```python
import torch

def _softmax(x, axis=-1):
    return torch.softmax(x, dim=axis)
def _gelu(x):
    return torch.nn.functional.gelu(x, approximate="tanh")
def _silu(x):
    return torch.nn.functional.silu(x)
def _sigmoid(x):
    return torch.sigmoid(x)
def _layernorm(x, axis=-1, eps=1e-5):
    m = x.mean(dim=axis, keepdim=True)
    v = x.var(dim=axis, keepdim=True, unbiased=False)
    return (x - m) / torch.sqrt(v + eps)
def _scatter_add(tgt, idx, src, axis=0):
    return tgt.clone().index_add_(axis, idx, src)
def _segment_sum(src, seg, n):
    out = torch.zeros((n,) + src.shape[1:], dtype=src.dtype)
    return out.index_add_(0, seg, src)
def _pad(x, pw):
    flat = tuple(v for pair in reversed(pw) for v in pair)
    return torch.nn.functional.pad(x, flat)

kernel_name = 'concat_heads__mha_block_cached__mha_block_cached__near_ridge'

def setup_inputs():

    _w = (lambda a: (lambda t: t.to(torch.bfloat16) if t.is_floating_point() else t)(torch.as_tensor(a)))
    def _A_setup():
        B, Sq, D = 32, 32, 576
        H, Sk, Dh = 32, 32, 128
        return {
            "x": _w((lambda *s: torch.randn(*s, dtype=torch.bfloat16) * 0.8)(B, Sq, D)),
            "k_cache": _w((lambda *s: torch.randn(*s, dtype=torch.bfloat16) * 0.8)(B, H, Sk, Dh)),
            "v_cache": _w((lambda *s: torch.randn(*s, dtype=torch.bfloat16) * 0.05)(B, H, Sk, Dh)),
            "wq": _w((lambda *s: torch.randn(*s, dtype=torch.bfloat16) * 0.8)(D, H * Dh) * (D ** -0.5)),
            "wo": _w((lambda *s: torch.randn(*s, dtype=torch.bfloat16) * 0.05)(H * Dh, D) * ((H * Dh) ** -0.5)),
        }
    _A_in = _A_setup()

    def _B_setup():
        B, Sq, D = 32, 32, 576
        H, Sk, Dh = 32, 32, 128
        return {
            "x": _w((lambda *s: torch.randn(*s, dtype=torch.bfloat16) * 0.8)(B, Sq, D)),
            "k_cache": _w((lambda *s: torch.randn(*s, dtype=torch.bfloat16) * 0.8)(B, H, Sk, Dh)),
            "v_cache": _w((lambda *s: torch.randn(*s, dtype=torch.bfloat16) * 0.05)(B, H, Sk, Dh)),
            "wq": _w((lambda *s: torch.randn(*s, dtype=torch.bfloat16) * 0.8)(D, H * Dh) * (D ** -0.5)),
            "wo": _w((lambda *s: torch.randn(*s, dtype=torch.bfloat16) * 0.05)(H * Dh, D) * ((H * Dh) ** -0.5)),
        }
    _B_in = _B_setup()

    return {
        "A_x": _A_in["x"],
        "A_k_cache": _A_in["k_cache"],
        "A_v_cache": _A_in["v_cache"],
        "A_wq": _A_in["wq"],
        "A_wo": _A_in["wo"],
        "B_x": _B_in["x"],
        "B_k_cache": _B_in["k_cache"],
        "B_v_cache": _B_in["v_cache"],
        "B_wq": _B_in["wq"],
        "B_wo": _B_in["wo"],
    }

def reference(A_x, A_k_cache, A_v_cache, A_wq, A_wo, B_x, B_k_cache, B_v_cache, B_wq, B_wo):
    def _A_ref(x, k_cache, v_cache, wq, wo):
        B, Sq, D = x.shape
        H, Dh = 32, 128
        q = (lambda x, *d: x.permute(*d))((x @ wq).reshape(B, Sq, H, Dh), 0, 2, 1, 3)
        scores = torch.einsum("bhqd,bhkd->bhqk", q, k_cache) * (Dh ** -0.5)
        p = _softmax(scores, axis=-1)
        o = torch.einsum("bhqk,bhkd->bhqd", p, v_cache)
        return (lambda x, *d: x.permute(*d))(o, 0, 2, 1, 3).reshape(B, Sq, H * Dh) @ wo

    def _B_ref(x, k_cache, v_cache, wq, wo):
        B, Sq, D = x.shape
        H, Dh = 32, 128
        q = (lambda x, *d: x.permute(*d))((x @ wq).reshape(B, Sq, H, Dh), 0, 2, 1, 3)
        scores = torch.einsum("bhqd,bhkd->bhqk", q, k_cache) * (Dh ** -0.5)
        p = _softmax(scores, axis=-1)
        o = torch.einsum("bhqk,bhkd->bhqd", p, v_cache)
        return (lambda x, *d: x.permute(*d))(o, 0, 2, 1, 3).reshape(B, Sq, H * Dh) @ wo

    a = _A_ref(A_x, A_k_cache, A_v_cache, A_wq, A_wo)
    b = _B_ref(B_x, B_k_cache, B_v_cache, B_wq, B_wo)
    return torch.concatenate([a, b], axis=-1)
```

```asm
; @launch grid=(256,1,1) block=(512,1,1) lds=163840
.amdgcn_target "amdgcn-amd-amdhsa--gfx950"
.text
.globl concat_heads__mha_block_cached__mha_block_cached__near_ridge_kernel
.p2align 8
.type concat_heads__mha_block_cached__mha_block_cached__near_ridge_kernel,@function
concat_heads__mha_block_cached__mha_block_cached__near_ridge_kernel:
s_and_b32 s25, s2, 4
s_mul_i32 s25, s25, 10
s_load_dwordx8 s[28:35], s[0:1], s25
s_lshr_b32 s3, s2, 8
s_cbranch_scc1 L_end
v_lshrrev_b32 v1, 6, v0
v_and_b32 v0, 63, v0
v_readfirstlane_b32 s40, v1
s_lshr_b32 s7, s2, 5
s_lshr_b32 s4, s2, 3
s_add_u32 s46, s4, s7
s_and_b32 s46, s46, 1
s_lshl_b32 s46, s46, 2
v_lshrrev_b32 v24, 3, v0
v_lshrrev_b32 v25, 4, v0
v_and_b32 v26, 7, v0
v_xor_b32 v26, v26, v25
v_mul_u32_u24 v24, 1152, v24
v_lshl_add_u32 v2, v26, 4, v24
v_xor_b32 v3, 64, v2
v_add_u32 v3, 8192, v3
s_lshl3_add_u32 s44, s7, s40
s_mulk_i32 s44, 18432
s_lshl_b32 s45, s46, 7
s_add_u32 s44, s44, s45
s_lshl_b32 m0, s40, 11
v_lshrrev_b32 v24, 5, v0
v_and_b32 v26, 31, v0
s_and_b32 s6, s40, 2
v_lshl_add_u32 v27, v24, 2, s6
v_xor_b32 v26, v26, v27
v_lshlrev_b32 v26, 4, v26
v_lshl_add_u32 v6, v24, 13, v26
v_xor_b32 v26, 128, v6
v_add_u32 v7, 15360, v26
s_and_b32 s6, s2, 3
s_and_b32 s24, s4, 3
s_lshl2_add_u32 s43, s6, s24
s_lshl4_add_u32 s45, s46, s40
s_lshl_b32 s45, s45, 6
s_add_u32 s45, s45, s43
s_lshl_b32 s45, s45, 9
s_waitcnt lgkmcnt(0)
s_add_u32 s8, s28, s44
s_addc_u32 s9, s29, 0
global_load_lds_dwordx4 v2, s[8:9]
global_load_lds_dwordx4 v3, s[8:9] offset:1024
s_bitset1_b32 m0, 15
s_add_u32 s12, s34, s45
s_addc_u32 s13, s35, 0
global_load_lds_dwordx4 v6, s[12:13]
global_load_lds_dwordx4 v7, s[12:13] offset:1024
L_first:

s_lshl_b32 s3, s24, 1
s_lshl3_add_u32 s43, s6, s3
s_add_u32 s25, s25, 32
s_load_dwordx2 s[36:37], s[0:1], s25
s_load_dwordx2 s[52:53], s[0:1], 80
s_load_dwordx2 s[38:39], s[0:1], 96
s_bfe_u32 s5, s2, 0x10002
s_cmp_lt_u32 s40, 4
s_cbranch_scc1 L_cons
s_sub_u32 s41, s40, 4
s_mul_i32 s42, s41, 36864
v_add_u32 v2, s42, v2
v_add_u32 v3, s42, v3
v_add_u32 v4, 16384, v2
v_add_u32 v5, 16384, v3
s_lshr_b32 s42, s41, 1
s_xor_b32 s42, s42, s41
s_and_b32 s42, s42, 1
s_lshl_b32 s42, s42, 5
v_xor_b32 v6, s42, v6
v_xor_b32 v7, s42, v7
s_lshl_b32 s42, s41, 16
v_add_u32 v6, s42, v6
v_add_u32 v7, s42, v7
v_add_u32 v8, 30720, v6
v_add_u32 v9, 30720, v7
s_lshl_b32 s42, s41, 12
s_mul_i32 s44, s7, 147456
s_lshl_b32 s45, s43, 8
s_add_u32 s8, s28, s44
s_addc_u32 s9, s29, 0
s_sub_u32 s10, 1179648, s44
s_mov_b32 s11, 0x20000
s_add_u32 s12, s34, s45
s_addc_u32 s13, s35, 0
s_sub_u32 s14, 4718592, s45
s_mov_b32 s15, 0x20000
s_add_u32 s47, s46, 1
s_cmp_eq_u32 s47, 9
s_cselect_b32 s47, 0, s47
s_add_u32 m0, s42, 49152
s_lshl_b32 s44, s46, 19
s_add_u32 s44, s44, 262144
buffer_load_dwordx4 v6, s[12:15], s44 offen offset:0 lds
buffer_load_dwordx4 v7, s[12:15], s44 offen offset:1024 lds
buffer_load_dwordx4 v8, s[12:15], s44 offen offset:2048 lds
buffer_load_dwordx4 v9, s[12:15], s44 offen offset:3072 lds
s_add_u32 s46, s46, 1
s_cmp_eq_u32 s46, 9
s_cselect_b32 s46, 0, s46
s_add_u32 m0, s42, 16384
s_lshl_b32 s44, s47, 7
buffer_load_dwordx4 v2, s[8:11], s44 offen offset:0 lds
buffer_load_dwordx4 v3, s[8:11], s44 offen offset:1024 lds
buffer_load_dwordx4 v4, s[8:11], s44 offen offset:2048 lds
buffer_load_dwordx4 v5, s[8:11], s44 offen offset:3072 lds
s_add_u32 s47, s47, 1
s_cmp_eq_u32 s47, 9
s_cselect_b32 s47, 0, s47
s_waitcnt lgkmcnt(0)
s_lshl_b32 s44, s7, 7
s_add_u32 s44, s44, s43
s_lshl_b32 s44, s44, 13
s_add_u32 s16, s30, s44
s_addc_u32 s17, s31, 0
s_sub_u32 s18, 8388608, s44
s_mov_b32 s19, 0x20000
v_lshrrev_b32 v24, 4, v0
v_and_b32 v26, 15, v0
v_xor_b32 v27, v26, v24
v_lshlrev_b32 v27, 4, v27
v_lshl_add_u32 v10, v24, 8, v27
v_xor_b32 v11, 64, v10
v_xor_b32 v12, 128, v10
v_xor_b32 v13, 192, v10
v_lshlrev_b32 v28, 2, v24
v_xor_b32 v28, v28, v26
v_lshlrev_b32 v28, 4, v28
v_lshl_add_u32 v14, v24, 8, v28
s_and_b32 s44, s41, 1
s_lshl_b32 s44, s44, 19
s_lshr_b32 s45, s41, 1
s_lshl_b32 s45, s45, 13
s_add_u32 s50, s44, s45
s_lshl_b32 s68, s41, 13
s_add_u32 s68, s68, 98304
s_lshr_b32 s44, s7, 1
s_and_b32 s44, s44, 1
s_cmp_eq_u32 s44, 1
s_cbranch_scc1 L_cls1
s_waitcnt vmcnt(8)
s_barrier
s_add_u32 m0, s42, 65536
s_lshl_b32 s44, s46, 19
buffer_load_dwordx4 v6, s[12:15], s44 offen offset:0 lds
buffer_load_dwordx4 v7, s[12:15], s44 offen offset:1024 lds
buffer_load_dwordx4 v8, s[12:15], s44 offen offset:2048 lds
buffer_load_dwordx4 v9, s[12:15], s44 offen offset:3072 lds
s_add_u32 m0, s42, 131072
s_lshl_b32 s44, s46, 19
s_add_u32 s44, s44, 262144
buffer_load_dwordx4 v6, s[12:15], s44 offen offset:0 lds
buffer_load_dwordx4 v7, s[12:15], s44 offen offset:1024 lds
buffer_load_dwordx4 v8, s[12:15], s44 offen offset:2048 lds
buffer_load_dwordx4 v9, s[12:15], s44 offen offset:3072 lds
s_add_u32 s46, s46, 1
s_cmp_eq_u32 s46, 9
s_cselect_b32 s46, 0, s46
s_add_u32 m0, s42, 147456
s_lshl_b32 s44, s46, 19
buffer_load_dwordx4 v6, s[12:15], s44 offen offset:0 lds
buffer_load_dwordx4 v7, s[12:15], s44 offen offset:1024 lds
buffer_load_dwordx4 v8, s[12:15], s44 offen offset:2048 lds
buffer_load_dwordx4 v9, s[12:15], s44 offen offset:3072 lds
s_waitcnt vmcnt(16)
s_barrier
s_add_u32 m0, s42, 81920
s_lshl_b32 s44, s47, 7
buffer_load_dwordx4 v2, s[8:11], s44 offen offset:0 lds
buffer_load_dwordx4 v3, s[8:11], s44 offen offset:1024 lds
buffer_load_dwordx4 v4, s[8:11], s44 offen offset:2048 lds
buffer_load_dwordx4 v5, s[8:11], s44 offen offset:3072 lds
s_add_u32 s47, s47, 1
s_cmp_eq_u32 s47, 9
s_cselect_b32 s47, 0, s47
s_add_u32 m0, s42, 32768
s_lshl_b32 s44, s46, 19
s_add_u32 s44, s44, 262144
buffer_load_dwordx4 v6, s[12:15], s44 offen offset:0 lds
buffer_load_dwordx4 v7, s[12:15], s44 offen offset:1024 lds
buffer_load_dwordx4 v8, s[12:15], s44 offen offset:2048 lds
buffer_load_dwordx4 v9, s[12:15], s44 offen offset:3072 lds
s_add_u32 s46, s46, 1
s_cmp_eq_u32 s46, 9
s_cselect_b32 s46, 0, s46
s_mov_b32 s20, s38
s_mov_b32 s21, s39
s_mov_b32 s22, 33554432
s_mov_b32 s23, 0x20000
s_lshl_b32 s48, s5, 5
s_lshl_b32 s44, s7, 2
s_add_u32 s48, s48, s44
s_lshl_b32 s48, s48, 5
s_lshl_b32 s44, s6, 3
s_add_u32 s48, s48, s44
s_lshl_b32 s48, s48, 11
s_and_b32 s49, s7, 1
s_lshl_b32 s44, s5, 3
s_add_u32 s44, s44, s7
s_lshl_b32 s44, s44, 7
s_add_u32 s88, s44, 4194304
s_add_u32 s44, s38, s88
s_addc_u32 s45, s39, 0
s_load_dword s89, s[44:45], 0
v_lshlrev_b32 v20, 4, v0
v_mov_b32 v21, 0
s_lshl_b32 s44, s7, 7
s_lshl_b32 s45, s6, 3
s_add_u32 s44, s44, s45
s_lshl_b32 s44, s44, 13
s_add_u32 s60, s32, s44
s_addc_u32 s61, s33, 0
s_sub_u32 s62, 8388608, s44
s_mov_b32 s63, 0x20000
s_lshl_b32 s44, s24, 1
s_add_u32 s64, s44, s49
s_xor_b32 s65, s64, 1
s_lshl_b32 s67, s41, 18
s_waitcnt vmcnt(16)
s_barrier
s_add_u32 m0, s42, 49152
s_lshl_b32 s44, s46, 19
buffer_load_dwordx4 v6, s[12:15], s44 offen offset:0 lds
buffer_load_dwordx4 v7, s[12:15], s44 offen offset:1024 lds
buffer_load_dwordx4 v8, s[12:15], s44 offen offset:2048 lds
buffer_load_dwordx4 v9, s[12:15], s44 offen offset:3072 lds
s_add_u32 m0, s42, 0
s_lshl_b32 s44, s47, 7
buffer_load_dwordx4 v2, s[8:11], s44 offen offset:0 lds
buffer_load_dwordx4 v3, s[8:11], s44 offen offset:1024 lds
buffer_load_dwordx4 v4, s[8:11], s44 offen offset:2048 lds
buffer_load_dwordx4 v5, s[8:11], s44 offen offset:3072 lds
s_add_u32 s47, s47, 1
s_cmp_eq_u32 s47, 9
s_cselect_b32 s47, 0, s47
s_waitcnt vmcnt(20)
s_barrier
s_add_u32 m0, s42, 65536
s_lshl_b32 s44, s46, 19
s_add_u32 s44, s44, 262144
buffer_load_dwordx4 v6, s[12:15], s44 offen offset:0 lds
buffer_load_dwordx4 v7, s[12:15], s44 offen offset:1024 lds
buffer_load_dwordx4 v8, s[12:15], s44 offen offset:2048 lds
buffer_load_dwordx4 v9, s[12:15], s44 offen offset:3072 lds
s_add_u32 s46, s46, 1
s_cmp_eq_u32 s46, 9
s_cselect_b32 s46, 0, s46
s_add_u32 m0, s68, 0
s_add_u32 s44, s50, 0
buffer_load_dwordx4 v10, s[16:19], s44 offen offset:0 nt lds
buffer_load_dwordx4 v11, s[16:19], s44 offen offset:1024 nt lds
buffer_load_dwordx4 v12, s[16:19], s44 offen offset:2048 nt lds
buffer_load_dwordx4 v13, s[16:19], s44 offen offset:3072 nt lds
s_add_u32 m0, s68, 4096
s_add_u32 s44, s50, 4096
buffer_load_dwordx4 v10, s[16:19], s44 offen offset:0 nt lds
buffer_load_dwordx4 v11, s[16:19], s44 offen offset:1024 nt lds
buffer_load_dwordx4 v12, s[16:19], s44 offen offset:2048 nt lds
buffer_load_dwordx4 v13, s[16:19], s44 offen offset:3072 nt lds
s_mul_i32 s44, s6, 1179648
s_lshl_b32 s45, s24, 8
s_add_u32 s44, s44, s45
s_add_u32 s56, s36, s44
s_addc_u32 s57, s37, 0
s_sub_u32 s58, 4718592, s44
s_mov_b32 s59, 0x20000
s_waitcnt vmcnt(24)
s_barrier
s_waitcnt vmcnt(20)
s_barrier
s_add_u32 m0, s42, 131072
s_lshl_b32 s44, s46, 19
buffer_load_dwordx4 v6, s[12:15], s44 offen offset:0 lds
buffer_load_dwordx4 v7, s[12:15], s44 offen offset:1024 lds
buffer_load_dwordx4 v8, s[12:15], s44 offen offset:2048 lds
buffer_load_dwordx4 v9, s[12:15], s44 offen offset:3072 lds
s_add_u32 m0, s42, 16384
s_lshl_b32 s44, s47, 7
buffer_load_dwordx4 v2, s[8:11], s44 offen offset:0 lds
buffer_load_dwordx4 v3, s[8:11], s44 offen offset:1024 lds
buffer_load_dwordx4 v4, s[8:11], s44 offen offset:2048 lds
buffer_load_dwordx4 v5, s[8:11], s44 offen offset:3072 lds
s_add_u32 s47, s47, 1
s_cmp_eq_u32 s47, 9
s_cselect_b32 s47, 0, s47
v_lshrrev_b32 v26, 4, v0
v_lshlrev_b32 v27, 2, v26
v_and_b32 v28, 15, v0
v_xor_b32 v27, v27, v28
v_mul_u32_u24 v26, 1152, v26
v_lshl_add_u32 v26, v27, 4, v26
s_mul_i32 s44, s41, 18432
v_add_u32 v15, s44, v26
v_add_u32 v16, 3584, v15
v_add_u32 v17, 7168, v15
v_add_u32 v18, 10752, v15
s_waitcnt vmcnt(8)
s_barrier
s_add_u32 m0, s42, 147456
s_lshl_b32 s44, s46, 19
s_add_u32 s44, s44, 262144
buffer_load_dwordx4 v6, s[12:15], s44 offen offset:0 lds
buffer_load_dwordx4 v7, s[12:15], s44 offen offset:1024 lds
buffer_load_dwordx4 v8, s[12:15], s44 offen offset:2048 lds
buffer_load_dwordx4 v9, s[12:15], s44 offen offset:3072 lds
s_add_u32 s46, s46, 1
s_cmp_eq_u32 s46, 9
s_cselect_b32 s46, 0, s46
s_add_u32 m0, s42, 32768
s_lshl_b32 s44, s46, 19
buffer_load_dwordx4 v6, s[12:15], s44 offen offset:0 lds
buffer_load_dwordx4 v7, s[12:15], s44 offen offset:1024 lds
buffer_load_dwordx4 v8, s[12:15], s44 offen offset:2048 lds
buffer_load_dwordx4 v9, s[12:15], s44 offen offset:3072 lds
s_waitcnt vmcnt(24)
s_barrier
s_add_u32 m0, s42, 81920
s_lshl_b32 s44, s47, 7
buffer_load_dwordx4 v2, s[8:11], s44 offen offset:0 lds
buffer_load_dwordx4 v3, s[8:11], s44 offen offset:1024 lds
buffer_load_dwordx4 v4, s[8:11], s44 offen offset:2048 lds
buffer_load_dwordx4 v5, s[8:11], s44 offen offset:3072 lds
s_add_u32 s47, s47, 1
s_cmp_eq_u32 s47, 9
s_cselect_b32 s47, 0, s47
s_add_u32 m0, s68, 0
s_add_u32 s44, s50, 262144
buffer_load_dwordx4 v10, s[16:19], s44 offen offset:0 nt lds
buffer_load_dwordx4 v11, s[16:19], s44 offen offset:1024 nt lds
buffer_load_dwordx4 v12, s[16:19], s44 offen offset:2048 nt lds
buffer_load_dwordx4 v13, s[16:19], s44 offen offset:3072 nt lds
s_add_u32 m0, s68, 4096
s_add_u32 s44, s50, 266240
buffer_load_dwordx4 v10, s[16:19], s44 offen offset:0 nt lds
buffer_load_dwordx4 v11, s[16:19], s44 offen offset:1024 nt lds
buffer_load_dwordx4 v12, s[16:19], s44 offen offset:2048 nt lds
buffer_load_dwordx4 v13, s[16:19], s44 offen offset:3072 nt lds
v_lshrrev_b32 v26, 3, v0
v_bfe_u32 v27, v0, 4, 1
v_lshlrev_b32 v27, 2, v27
v_and_b32 v28, 7, v0
v_xor_b32 v27, v27, v28
v_mul_u32_u24 v26, 1152, v26
v_lshl_add_u32 v26, v27, 4, v26
s_mul_i32 s44, s41, 36864
s_lshl_b32 s45, s24, 8
s_sub_u32 s44, s44, s45
s_add_u32 s44, s44, 1024
v_add_u32 v48, s44, v26
v_add_u32 v49, 8192, v48
v_add_u32 v50, 16384, v48
v_add_u32 v51, 24576, v48
s_waitcnt vmcnt(20)
s_barrier
s_waitcnt vmcnt(16)
s_barrier
s_add_u32 m0, s42, 49152
s_lshl_b32 s44, s46, 19
s_add_u32 s44, s44, 262144
buffer_load_dwordx4 v6, s[12:15], s44 offen offset:0 lds
buffer_load_dwordx4 v7, s[12:15], s44 offen offset:1024 lds
buffer_load_dwordx4 v8, s[12:15], s44 offen offset:2048 lds
buffer_load_dwordx4 v9, s[12:15], s44 offen offset:3072 lds
s_add_u32 s46, s46, 1
s_cmp_eq_u32 s46, 9
s_cselect_b32 s46, 0, s46
s_add_u32 m0, s42, 65536
s_lshl_b32 s44, s46, 19
buffer_load_dwordx4 v6, s[12:15], s44 offen offset:0 lds
buffer_load_dwordx4 v7, s[12:15], s44 offen offset:1024 lds
buffer_load_dwordx4 v8, s[12:15], s44 offen offset:2048 lds
buffer_load_dwordx4 v9, s[12:15], s44 offen offset:3072 lds
s_sub_u32 s44, s7, 6
s_cmp_ge_u32 s7, 6
s_cselect_b32 s45, s44, s7
s_lshl_b32 s44, s24, 1
s_add_u32 s44, s44, s45
s_add_u32 s44, s44, 2
s_and_b32 s82, s44, 7
s_add_u32 s45, s45, 1
s_cmp_eq_u32 s45, 6
s_cselect_b32 s45, 0, s45
s_lshl_b32 s44, s24, 1
s_add_u32 s44, s44, s45
s_add_u32 s44, s44, 2
s_and_b32 s83, s44, 7
s_add_u32 s45, s45, 1
s_cmp_eq_u32 s45, 6
s_cselect_b32 s45, 0, s45
s_lshl_b32 s44, s24, 1
s_add_u32 s44, s44, s45
s_add_u32 s44, s44, 2
s_and_b32 s84, s44, 7
s_add_u32 s45, s45, 1
s_cmp_eq_u32 s45, 6
s_cselect_b32 s45, 0, s45
s_lshl_b32 s44, s24, 1
s_add_u32 s44, s44, s45
s_add_u32 s44, s44, 2
s_and_b32 s85, s44, 7
s_add_u32 s45, s45, 1
s_cmp_eq_u32 s45, 6
s_cselect_b32 s45, 0, s45
s_lshl_b32 s44, s24, 1
s_add_u32 s44, s44, s45
s_add_u32 s44, s44, 2
s_and_b32 s86, s44, 7
s_add_u32 s45, s45, 1
s_cmp_eq_u32 s45, 6
s_cselect_b32 s45, 0, s45
s_lshl_b32 s44, s24, 1
s_add_u32 s44, s44, s45
s_add_u32 s44, s44, 2
s_and_b32 s87, s44, 7
s_waitcnt vmcnt(8)
s_barrier
s_add_u32 m0, s42, 0
s_lshl_b32 s44, s47, 7
buffer_load_dwordx4 v2, s[8:11], s44 offen offset:0 lds
buffer_load_dwordx4 v3, s[8:11], s44 offen offset:1024 lds
buffer_load_dwordx4 v4, s[8:11], s44 offen offset:2048 lds
buffer_load_dwordx4 v5, s[8:11], s44 offen offset:3072 lds
s_add_u32 s47, s47, 1
s_cmp_eq_u32 s47, 9
s_cselect_b32 s47, 0, s47
s_add_u32 m0, s42, 131072
s_lshl_b32 s44, s46, 19
s_add_u32 s44, s44, 262144
buffer_load_dwordx4 v6, s[12:15], s44 offen offset:0 lds
buffer_load_dwordx4 v7, s[12:15], s44 offen offset:1024 lds
buffer_load_dwordx4 v8, s[12:15], s44 offen offset:2048 lds
buffer_load_dwordx4 v9, s[12:15], s44 offen offset:3072 lds
s_add_u32 s46, s46, 1
s_cmp_eq_u32 s46, 9
s_cselect_b32 s46, 0, s46
s_waitcnt vmcnt(12)
s_barrier
s_add_u32 m0, s42, 147456
s_lshl_b32 s44, s46, 19
buffer_load_dwordx4 v6, s[12:15], s44 offen offset:0 lds
buffer_load_dwordx4 v7, s[12:15], s44 offen offset:1024 lds
buffer_load_dwordx4 v8, s[12:15], s44 offen offset:2048 lds
buffer_load_dwordx4 v9, s[12:15], s44 offen offset:3072 lds
s_add_u32 m0, s68, 0
s_lshl_b32 s44, s64, 13
s_add_u32 s44, s44, s67
buffer_load_dwordx4 v14, s[60:63], s44 offen offset:0 lds
buffer_load_dwordx4 v14, s[60:63], s44 offen offset:1024 lds
buffer_load_dwordx4 v14, s[60:63], s44 offen offset:2048 lds
buffer_load_dwordx4 v14, s[60:63], s44 offen offset:3072 lds
s_add_u32 m0, s68, 4096
s_lshl_b32 s44, s64, 13
s_add_u32 s44, s44, s67
s_add_u32 s44, s44, 4096
buffer_load_dwordx4 v14, s[60:63], s44 offen offset:0 lds
buffer_load_dwordx4 v14, s[60:63], s44 offen offset:1024 lds
buffer_load_dwordx4 v14, s[60:63], s44 offen offset:2048 lds
buffer_load_dwordx4 v14, s[60:63], s44 offen offset:3072 lds
s_lshl_b32 s70, s41, 11
s_add_u32 s70, s70, 81920
s_lshl_b32 s71, s41, 16
s_add_u32 s71, s71, s48
s_waitcnt lgkmcnt(0)
s_add_u32 s51, s89, 1
v_and_b32 v24, 3, v0
v_mul_u32_u24 v26, 0x55, v24
v_add_u32 v26, s51, v26
v_lshlrev_b32 v32, 15, v26
v_and_b32 v32, 0x8000, v32
v_lshlrev_b32 v27, 30, v26
v_and_b32 v27, 0x80000000, v27
v_or_b32 v32, v32, v27
v_lshlrev_b32 v33, 13, v26
v_and_b32 v33, 0x8000, v33
v_lshlrev_b32 v27, 28, v26
v_and_b32 v27, 0x80000000, v27
v_or_b32 v33, v33, v27
v_lshlrev_b32 v34, 11, v26
v_and_b32 v34, 0x8000, v34
v_lshlrev_b32 v27, 26, v26
v_and_b32 v27, 0x80000000, v27
v_or_b32 v34, v34, v27
v_lshlrev_b32 v35, 9, v26
v_and_b32 v35, 0x8000, v35
v_lshlrev_b32 v27, 24, v26
v_and_b32 v27, 0x80000000, v27
v_or_b32 v35, v35, v27
v_add_u32 v25, s70, v20
s_mov_b32 s43, 0x80008000
s_waitcnt vmcnt(16)
s_barrier
s_waitcnt vmcnt(12)
s_barrier
s_add_u32 m0, s42, 16384
s_lshl_b32 s44, s47, 7
buffer_load_dwordx4 v2, s[8:11], s44 offen offset:0 lds
buffer_load_dwordx4 v3, s[8:11], s44 offen offset:1024 lds
buffer_load_dwordx4 v4, s[8:11], s44 offen offset:2048 lds
buffer_load_dwordx4 v5, s[8:11], s44 offen offset:3072 lds
s_add_u32 s47, s47, 1
s_cmp_eq_u32 s47, 9
s_cselect_b32 s47, 0, s47
s_add_u32 m0, s42, 32768
s_lshl_b32 s44, s46, 19
s_add_u32 s44, s44, 262144
buffer_load_dwordx4 v6, s[12:15], s44 offen offset:0 lds
buffer_load_dwordx4 v7, s[12:15], s44 offen offset:1024 lds
buffer_load_dwordx4 v8, s[12:15], s44 offen offset:2048 lds
buffer_load_dwordx4 v9, s[12:15], s44 offen offset:3072 lds
s_add_u32 s46, s46, 1
s_cmp_eq_u32 s46, 9
s_cselect_b32 s46, 0, s46
s_waitcnt vmcnt(4)
s_barrier
s_add_u32 m0, s42, 49152
s_lshl_b32 s44, s46, 19
buffer_load_dwordx4 v6, s[12:15], s44 offen offset:0 lds
buffer_load_dwordx4 v7, s[12:15], s44 offen offset:1024 lds
buffer_load_dwordx4 v8, s[12:15], s44 offen offset:2048 lds
buffer_load_dwordx4 v9, s[12:15], s44 offen offset:3072 lds
s_add_u32 m0, s42, 81920
s_lshl_b32 s44, s47, 7
buffer_load_dwordx4 v2, s[8:11], s44 offen offset:0 lds
buffer_load_dwordx4 v3, s[8:11], s44 offen offset:1024 lds
buffer_load_dwordx4 v4, s[8:11], s44 offen offset:2048 lds
buffer_load_dwordx4 v5, s[8:11], s44 offen offset:3072 lds
s_add_u32 s47, s47, 1
s_cmp_eq_u32 s47, 9
s_cselect_b32 s47, 0, s47
s_waitcnt vmcnt(8)
s_barrier
s_add_u32 m0, s42, 65536
s_lshl_b32 s44, s46, 19
s_add_u32 s44, s44, 262144
buffer_load_dwordx4 v6, s[12:15], s44 offen offset:0 lds
buffer_load_dwordx4 v7, s[12:15], s44 offen offset:1024 lds
buffer_load_dwordx4 v8, s[12:15], s44 offen offset:2048 lds
buffer_load_dwordx4 v9, s[12:15], s44 offen offset:3072 lds
s_add_u32 s46, s46, 1
s_cmp_eq_u32 s46, 9
s_cselect_b32 s46, 0, s46
s_add_u32 m0, s68, 32768
s_lshl_b32 s44, s65, 13
s_add_u32 s44, s44, s67
buffer_load_dwordx4 v14, s[60:63], s44 offen offset:0 lds
buffer_load_dwordx4 v14, s[60:63], s44 offen offset:1024 lds
buffer_load_dwordx4 v14, s[60:63], s44 offen offset:2048 lds
buffer_load_dwordx4 v14, s[60:63], s44 offen offset:3072 lds
s_add_u32 m0, s68, 36864
s_lshl_b32 s44, s65, 13
s_add_u32 s44, s44, s67
s_add_u32 s44, s44, 4096
buffer_load_dwordx4 v14, s[60:63], s44 offen offset:0 lds
buffer_load_dwordx4 v14, s[60:63], s44 offen offset:1024 lds
buffer_load_dwordx4 v14, s[60:63], s44 offen offset:2048 lds
buffer_load_dwordx4 v14, s[60:63], s44 offen offset:3072 lds
s_waitcnt vmcnt(12)
s_barrier
s_waitcnt vmcnt(8)
s_barrier
s_barrier
s_add_u32 m0, s42, 0
s_mul_i32 s44, s64, 147456
buffer_load_dwordx4 v15, s[56:59], s44 offen offset:0 lds
buffer_load_dwordx4 v16, s[56:59], s44 offen offset:1024 lds
buffer_load_dwordx4 v17, s[56:59], s44 offen offset:2048 lds
buffer_load_dwordx4 v18, s[56:59], s44 offen offset:3072 lds
s_add_u32 m0, s42, 65536
s_mul_i32 s44, s64, 147456
buffer_load_dwordx4 v48, s[56:59], s44 offen offset:0 lds
buffer_load_dwordx4 v49, s[56:59], s44 offen offset:1024 lds
buffer_load_dwordx4 v50, s[56:59], s44 offen offset:2048 lds
buffer_load_dwordx4 v51, s[56:59], s44 offen offset:3072 lds
s_add_u32 m0, s42, 16384
s_mul_i32 s44, s64, 147456
s_add_u32 s44, s44, 73728
buffer_load_dwordx4 v15, s[56:59], s44 offen offset:0 lds
buffer_load_dwordx4 v16, s[56:59], s44 offen offset:1024 lds
buffer_load_dwordx4 v17, s[56:59], s44 offen offset:2048 lds
buffer_load_dwordx4 v18, s[56:59], s44 offen offset:3072 lds
s_waitcnt vmcnt(4)
s_barrier
s_branch L_ph2
L_cls1:
s_waitcnt vmcnt(8)
s_barrier
s_add_u32 m0, s42, 65536
s_lshl_b32 s44, s46, 19
buffer_load_dwordx4 v6, s[12:15], s44 offen offset:0 lds
buffer_load_dwordx4 v7, s[12:15], s44 offen offset:1024 lds
buffer_load_dwordx4 v8, s[12:15], s44 offen offset:2048 lds
buffer_load_dwordx4 v9, s[12:15], s44 offen offset:3072 lds
s_add_u32 m0, s42, 131072
s_lshl_b32 s44, s46, 19
s_add_u32 s44, s44, 262144
buffer_load_dwordx4 v6, s[12:15], s44 offen offset:0 lds
buffer_load_dwordx4 v7, s[12:15], s44 offen offset:1024 lds
buffer_load_dwordx4 v8, s[12:15], s44 offen offset:2048 lds
buffer_load_dwordx4 v9, s[12:15], s44 offen offset:3072 lds
s_add_u32 s46, s46, 1
s_cmp_eq_u32 s46, 9
s_cselect_b32 s46, 0, s46
s_add_u32 m0, s42, 147456
s_lshl_b32 s44, s46, 19
buffer_load_dwordx4 v6, s[12:15], s44 offen offset:0 lds
buffer_load_dwordx4 v7, s[12:15], s44 offen offset:1024 lds
buffer_load_dwordx4 v8, s[12:15], s44 offen offset:2048 lds
buffer_load_dwordx4 v9, s[12:15], s44 offen offset:3072 lds
s_waitcnt vmcnt(16)
s_barrier
s_add_u32 m0, s42, 81920
s_lshl_b32 s44, s47, 7
buffer_load_dwordx4 v2, s[8:11], s44 offen offset:0 lds
buffer_load_dwordx4 v3, s[8:11], s44 offen offset:1024 lds
buffer_load_dwordx4 v4, s[8:11], s44 offen offset:2048 lds
buffer_load_dwordx4 v5, s[8:11], s44 offen offset:3072 lds
s_add_u32 s47, s47, 1
s_cmp_eq_u32 s47, 9
s_cselect_b32 s47, 0, s47
s_add_u32 m0, s42, 32768
s_lshl_b32 s44, s46, 19
s_add_u32 s44, s44, 262144
buffer_load_dwordx4 v6, s[12:15], s44 offen offset:0 lds
buffer_load_dwordx4 v7, s[12:15], s44 offen offset:1024 lds
buffer_load_dwordx4 v8, s[12:15], s44 offen offset:2048 lds
buffer_load_dwordx4 v9, s[12:15], s44 offen offset:3072 lds
s_add_u32 s46, s46, 1
s_cmp_eq_u32 s46, 9
s_cselect_b32 s46, 0, s46
s_mov_b32 s20, s38
s_mov_b32 s21, s39
s_mov_b32 s22, 33554432
s_mov_b32 s23, 0x20000
s_lshl_b32 s48, s5, 5
s_lshl_b32 s44, s7, 2
s_add_u32 s48, s48, s44
s_lshl_b32 s48, s48, 5
s_lshl_b32 s44, s6, 3
s_add_u32 s48, s48, s44
s_lshl_b32 s48, s48, 11
s_and_b32 s49, s7, 1
s_lshl_b32 s44, s5, 3
s_add_u32 s44, s44, s7
s_lshl_b32 s44, s44, 7
s_add_u32 s88, s44, 4194304
s_add_u32 s44, s38, s88
s_addc_u32 s45, s39, 0
s_load_dword s89, s[44:45], 0
v_lshlrev_b32 v20, 4, v0
v_mov_b32 v21, 0
s_lshl_b32 s44, s7, 7
s_lshl_b32 s45, s6, 3
s_add_u32 s44, s44, s45
s_lshl_b32 s44, s44, 13
s_add_u32 s60, s32, s44
s_addc_u32 s61, s33, 0
s_sub_u32 s62, 8388608, s44
s_mov_b32 s63, 0x20000
s_lshl_b32 s44, s24, 1
s_add_u32 s64, s44, s49
s_xor_b32 s65, s64, 1
s_lshl_b32 s67, s41, 18
s_waitcnt vmcnt(16)
s_barrier
s_add_u32 m0, s42, 49152
s_lshl_b32 s44, s46, 19
buffer_load_dwordx4 v6, s[12:15], s44 offen offset:0 lds
buffer_load_dwordx4 v7, s[12:15], s44 offen offset:1024 lds
buffer_load_dwordx4 v8, s[12:15], s44 offen offset:2048 lds
buffer_load_dwordx4 v9, s[12:15], s44 offen offset:3072 lds
s_add_u32 m0, s42, 0
s_lshl_b32 s44, s47, 7
buffer_load_dwordx4 v2, s[8:11], s44 offen offset:0 lds
buffer_load_dwordx4 v3, s[8:11], s44 offen offset:1024 lds
buffer_load_dwordx4 v4, s[8:11], s44 offen offset:2048 lds
buffer_load_dwordx4 v5, s[8:11], s44 offen offset:3072 lds
s_add_u32 s47, s47, 1
s_cmp_eq_u32 s47, 9
s_cselect_b32 s47, 0, s47
s_waitcnt vmcnt(20)
s_barrier
s_add_u32 m0, s42, 65536
s_lshl_b32 s44, s46, 19
s_add_u32 s44, s44, 262144
buffer_load_dwordx4 v6, s[12:15], s44 offen offset:0 lds
buffer_load_dwordx4 v7, s[12:15], s44 offen offset:1024 lds
buffer_load_dwordx4 v8, s[12:15], s44 offen offset:2048 lds
buffer_load_dwordx4 v9, s[12:15], s44 offen offset:3072 lds
s_add_u32 s46, s46, 1
s_cmp_eq_u32 s46, 9
s_cselect_b32 s46, 0, s46
s_mul_i32 s44, s6, 1179648
s_lshl_b32 s45, s24, 8
s_add_u32 s44, s44, s45
s_add_u32 s56, s36, s44
s_addc_u32 s57, s37, 0
s_sub_u32 s58, 4718592, s44
s_mov_b32 s59, 0x20000
s_waitcnt vmcnt(16)
s_barrier
s_add_u32 m0, s42, 131072
s_lshl_b32 s44, s46, 19
buffer_load_dwordx4 v6, s[12:15], s44 offen offset:0 lds
buffer_load_dwordx4 v7, s[12:15], s44 offen offset:1024 lds
buffer_load_dwordx4 v8, s[12:15], s44 offen offset:2048 lds
buffer_load_dwordx4 v9, s[12:15], s44 offen offset:3072 lds
s_add_u32 m0, s42, 16384
s_lshl_b32 s44, s47, 7
buffer_load_dwordx4 v2, s[8:11], s44 offen offset:0 lds
buffer_load_dwordx4 v3, s[8:11], s44 offen offset:1024 lds
buffer_load_dwordx4 v4, s[8:11], s44 offen offset:2048 lds
buffer_load_dwordx4 v5, s[8:11], s44 offen offset:3072 lds
s_add_u32 s47, s47, 1
s_cmp_eq_u32 s47, 9
s_cselect_b32 s47, 0, s47
s_waitcnt vmcnt(20)
s_barrier
s_add_u32 m0, s42, 147456
s_lshl_b32 s44, s46, 19
s_add_u32 s44, s44, 262144
buffer_load_dwordx4 v6, s[12:15], s44 offen offset:0 lds
buffer_load_dwordx4 v7, s[12:15], s44 offen offset:1024 lds
buffer_load_dwordx4 v8, s[12:15], s44 offen offset:2048 lds
buffer_load_dwordx4 v9, s[12:15], s44 offen offset:3072 lds
s_add_u32 s46, s46, 1
s_cmp_eq_u32 s46, 9
s_cselect_b32 s46, 0, s46
s_add_u32 m0, s68, 0
s_add_u32 s44, s50, 0
buffer_load_dwordx4 v10, s[16:19], s44 offen offset:0 nt lds
buffer_load_dwordx4 v11, s[16:19], s44 offen offset:1024 nt lds
buffer_load_dwordx4 v12, s[16:19], s44 offen offset:2048 nt lds
buffer_load_dwordx4 v13, s[16:19], s44 offen offset:3072 nt lds
s_add_u32 m0, s68, 4096
s_add_u32 s44, s50, 4096
buffer_load_dwordx4 v10, s[16:19], s44 offen offset:0 nt lds
buffer_load_dwordx4 v11, s[16:19], s44 offen offset:1024 nt lds
buffer_load_dwordx4 v12, s[16:19], s44 offen offset:2048 nt lds
buffer_load_dwordx4 v13, s[16:19], s44 offen offset:3072 nt lds
v_lshrrev_b32 v26, 4, v0
v_lshlrev_b32 v27, 2, v26
v_and_b32 v28, 15, v0
v_xor_b32 v27, v27, v28
v_mul_u32_u24 v26, 1152, v26
v_lshl_add_u32 v26, v27, 4, v26
s_mul_i32 s44, s41, 18432
v_add_u32 v15, s44, v26
v_add_u32 v16, 3584, v15
v_add_u32 v17, 7168, v15
v_add_u32 v18, 10752, v15
s_waitcnt vmcnt(24)
s_barrier
s_waitcnt vmcnt(20)
s_barrier
s_add_u32 m0, s42, 32768
s_lshl_b32 s44, s46, 19
buffer_load_dwordx4 v6, s[12:15], s44 offen offset:0 lds
buffer_load_dwordx4 v7, s[12:15], s44 offen offset:1024 lds
buffer_load_dwordx4 v8, s[12:15], s44 offen offset:2048 lds
buffer_load_dwordx4 v9, s[12:15], s44 offen offset:3072 lds
s_add_u32 m0, s42, 81920
s_lshl_b32 s44, s47, 7
buffer_load_dwordx4 v2, s[8:11], s44 offen offset:0 lds
buffer_load_dwordx4 v3, s[8:11], s44 offen offset:1024 lds
buffer_load_dwordx4 v4, s[8:11], s44 offen offset:2048 lds
buffer_load_dwordx4 v5, s[8:11], s44 offen offset:3072 lds
s_add_u32 s47, s47, 1
s_cmp_eq_u32 s47, 9
s_cselect_b32 s47, 0, s47
v_lshrrev_b32 v26, 3, v0
v_bfe_u32 v27, v0, 4, 1
v_lshlrev_b32 v27, 2, v27
v_and_b32 v28, 7, v0
v_xor_b32 v27, v27, v28
v_mul_u32_u24 v26, 1152, v26
v_lshl_add_u32 v26, v27, 4, v26
s_mul_i32 s44, s41, 36864
s_lshl_b32 s45, s24, 8
s_sub_u32 s44, s44, s45
s_add_u32 s44, s44, 1024
v_add_u32 v48, s44, v26
v_add_u32 v49, 8192, v48
v_add_u32 v50, 16384, v48
v_add_u32 v51, 24576, v48
s_waitcnt vmcnt(8)
s_barrier
s_add_u32 m0, s42, 49152
s_lshl_b32 s44, s46, 19
s_add_u32 s44, s44, 262144
buffer_load_dwordx4 v6, s[12:15], s44 offen offset:0 lds
buffer_load_dwordx4 v7, s[12:15], s44 offen offset:1024 lds
buffer_load_dwordx4 v8, s[12:15], s44 offen offset:2048 lds
buffer_load_dwordx4 v9, s[12:15], s44 offen offset:3072 lds
s_add_u32 s46, s46, 1
s_cmp_eq_u32 s46, 9
s_cselect_b32 s46, 0, s46
s_add_u32 m0, s42, 65536
s_lshl_b32 s44, s46, 19
buffer_load_dwordx4 v6, s[12:15], s44 offen offset:0 lds
buffer_load_dwordx4 v7, s[12:15], s44 offen offset:1024 lds
buffer_load_dwordx4 v8, s[12:15], s44 offen offset:2048 lds
buffer_load_dwordx4 v9, s[12:15], s44 offen offset:3072 lds
s_waitcnt vmcnt(24)
s_barrier
s_add_u32 m0, s42, 0
s_lshl_b32 s44, s47, 7
buffer_load_dwordx4 v2, s[8:11], s44 offen offset:0 lds
buffer_load_dwordx4 v3, s[8:11], s44 offen offset:1024 lds
buffer_load_dwordx4 v4, s[8:11], s44 offen offset:2048 lds
buffer_load_dwordx4 v5, s[8:11], s44 offen offset:3072 lds
s_add_u32 s47, s47, 1
s_cmp_eq_u32 s47, 9
s_cselect_b32 s47, 0, s47
s_add_u32 m0, s68, 0
s_add_u32 s44, s50, 262144
buffer_load_dwordx4 v10, s[16:19], s44 offen offset:0 nt lds
buffer_load_dwordx4 v11, s[16:19], s44 offen offset:1024 nt lds
buffer_load_dwordx4 v12, s[16:19], s44 offen offset:2048 nt lds
buffer_load_dwordx4 v13, s[16:19], s44 offen offset:3072 nt lds
s_add_u32 m0, s68, 4096
s_add_u32 s44, s50, 266240
buffer_load_dwordx4 v10, s[16:19], s44 offen offset:0 nt lds
buffer_load_dwordx4 v11, s[16:19], s44 offen offset:1024 nt lds
buffer_load_dwordx4 v12, s[16:19], s44 offen offset:2048 nt lds
buffer_load_dwordx4 v13, s[16:19], s44 offen offset:3072 nt lds
s_sub_u32 s44, s7, 6
s_cmp_ge_u32 s7, 6
s_cselect_b32 s45, s44, s7
s_lshl_b32 s44, s24, 1
s_add_u32 s44, s44, s45
s_add_u32 s44, s44, 2
s_and_b32 s82, s44, 7
s_add_u32 s45, s45, 1
s_cmp_eq_u32 s45, 6
s_cselect_b32 s45, 0, s45
s_lshl_b32 s44, s24, 1
s_add_u32 s44, s44, s45
s_add_u32 s44, s44, 2
s_and_b32 s83, s44, 7
s_add_u32 s45, s45, 1
s_cmp_eq_u32 s45, 6
s_cselect_b32 s45, 0, s45
s_lshl_b32 s44, s24, 1
s_add_u32 s44, s44, s45
s_add_u32 s44, s44, 2
s_and_b32 s84, s44, 7
s_add_u32 s45, s45, 1
s_cmp_eq_u32 s45, 6
s_cselect_b32 s45, 0, s45
s_lshl_b32 s44, s24, 1
s_add_u32 s44, s44, s45
s_add_u32 s44, s44, 2
s_and_b32 s85, s44, 7
s_add_u32 s45, s45, 1
s_cmp_eq_u32 s45, 6
s_cselect_b32 s45, 0, s45
s_lshl_b32 s44, s24, 1
s_add_u32 s44, s44, s45
s_add_u32 s44, s44, 2
s_and_b32 s86, s44, 7
s_add_u32 s45, s45, 1
s_cmp_eq_u32 s45, 6
s_cselect_b32 s45, 0, s45
s_lshl_b32 s44, s24, 1
s_add_u32 s44, s44, s45
s_add_u32 s44, s44, 2
s_and_b32 s87, s44, 7
s_waitcnt vmcnt(20)
s_barrier
s_waitcnt vmcnt(16)
s_barrier
s_add_u32 m0, s42, 131072
s_lshl_b32 s44, s46, 19
s_add_u32 s44, s44, 262144
buffer_load_dwordx4 v6, s[12:15], s44 offen offset:0 lds
buffer_load_dwordx4 v7, s[12:15], s44 offen offset:1024 lds
buffer_load_dwordx4 v8, s[12:15], s44 offen offset:2048 lds
buffer_load_dwordx4 v9, s[12:15], s44 offen offset:3072 lds
s_add_u32 s46, s46, 1
s_cmp_eq_u32 s46, 9
s_cselect_b32 s46, 0, s46
s_add_u32 m0, s42, 147456
s_lshl_b32 s44, s46, 19
buffer_load_dwordx4 v6, s[12:15], s44 offen offset:0 lds
buffer_load_dwordx4 v7, s[12:15], s44 offen offset:1024 lds
buffer_load_dwordx4 v8, s[12:15], s44 offen offset:2048 lds
buffer_load_dwordx4 v9, s[12:15], s44 offen offset:3072 lds
s_lshl_b32 s70, s41, 11
s_add_u32 s70, s70, 81920
s_lshl_b32 s71, s41, 16
s_add_u32 s71, s71, s48
s_waitcnt lgkmcnt(0)
s_add_u32 s51, s89, 1
v_and_b32 v24, 3, v0
v_mul_u32_u24 v26, 0x55, v24
v_add_u32 v26, s51, v26
v_lshlrev_b32 v32, 15, v26
v_and_b32 v32, 0x8000, v32
v_lshlrev_b32 v27, 30, v26
v_and_b32 v27, 0x80000000, v27
v_or_b32 v32, v32, v27
v_lshlrev_b32 v33, 13, v26
v_and_b32 v33, 0x8000, v33
v_lshlrev_b32 v27, 28, v26
v_and_b32 v27, 0x80000000, v27
v_or_b32 v33, v33, v27
v_lshlrev_b32 v34, 11, v26
v_and_b32 v34, 0x8000, v34
v_lshlrev_b32 v27, 26, v26
v_and_b32 v27, 0x80000000, v27
v_or_b32 v34, v34, v27
v_lshlrev_b32 v35, 9, v26
v_and_b32 v35, 0x8000, v35
v_lshlrev_b32 v27, 24, v26
v_and_b32 v27, 0x80000000, v27
v_or_b32 v35, v35, v27
v_add_u32 v25, s70, v20
s_mov_b32 s43, 0x80008000
s_waitcnt vmcnt(8)
s_barrier
s_add_u32 m0, s42, 16384
s_lshl_b32 s44, s47, 7
buffer_load_dwordx4 v2, s[8:11], s44 offen offset:0 lds
buffer_load_dwordx4 v3, s[8:11], s44 offen offset:1024 lds
buffer_load_dwordx4 v4, s[8:11], s44 offen offset:2048 lds
buffer_load_dwordx4 v5, s[8:11], s44 offen offset:3072 lds
s_add_u32 s47, s47, 1
s_cmp_eq_u32 s47, 9
s_cselect_b32 s47, 0, s47
s_add_u32 m0, s42, 32768
s_lshl_b32 s44, s46, 19
s_add_u32 s44, s44, 262144
buffer_load_dwordx4 v6, s[12:15], s44 offen offset:0 lds
buffer_load_dwordx4 v7, s[12:15], s44 offen offset:1024 lds
buffer_load_dwordx4 v8, s[12:15], s44 offen offset:2048 lds
buffer_load_dwordx4 v9, s[12:15], s44 offen offset:3072 lds
s_add_u32 s46, s46, 1
s_cmp_eq_u32 s46, 9
s_cselect_b32 s46, 0, s46
s_waitcnt vmcnt(12)
s_barrier
s_add_u32 m0, s42, 49152
s_lshl_b32 s44, s46, 19
buffer_load_dwordx4 v6, s[12:15], s44 offen offset:0 lds
buffer_load_dwordx4 v7, s[12:15], s44 offen offset:1024 lds
buffer_load_dwordx4 v8, s[12:15], s44 offen offset:2048 lds
buffer_load_dwordx4 v9, s[12:15], s44 offen offset:3072 lds
s_add_u32 m0, s68, 0
s_lshl_b32 s44, s64, 13
s_add_u32 s44, s44, s67
buffer_load_dwordx4 v14, s[60:63], s44 offen offset:0 lds
buffer_load_dwordx4 v14, s[60:63], s44 offen offset:1024 lds
buffer_load_dwordx4 v14, s[60:63], s44 offen offset:2048 lds
buffer_load_dwordx4 v14, s[60:63], s44 offen offset:3072 lds
s_add_u32 m0, s68, 4096
s_lshl_b32 s44, s64, 13
s_add_u32 s44, s44, s67
s_add_u32 s44, s44, 4096
buffer_load_dwordx4 v14, s[60:63], s44 offen offset:0 lds
buffer_load_dwordx4 v14, s[60:63], s44 offen offset:1024 lds
buffer_load_dwordx4 v14, s[60:63], s44 offen offset:2048 lds
buffer_load_dwordx4 v14, s[60:63], s44 offen offset:3072 lds
s_waitcnt vmcnt(16)
s_barrier
s_waitcnt vmcnt(12)
s_barrier
s_add_u32 m0, s42, 81920
s_lshl_b32 s44, s47, 7
buffer_load_dwordx4 v2, s[8:11], s44 offen offset:0 lds
buffer_load_dwordx4 v3, s[8:11], s44 offen offset:1024 lds
buffer_load_dwordx4 v4, s[8:11], s44 offen offset:2048 lds
buffer_load_dwordx4 v5, s[8:11], s44 offen offset:3072 lds
s_add_u32 s47, s47, 1
s_cmp_eq_u32 s47, 9
s_cselect_b32 s47, 0, s47
s_add_u32 m0, s42, 65536
s_lshl_b32 s44, s46, 19
s_add_u32 s44, s44, 262144
buffer_load_dwordx4 v6, s[12:15], s44 offen offset:0 lds
buffer_load_dwordx4 v7, s[12:15], s44 offen offset:1024 lds
buffer_load_dwordx4 v8, s[12:15], s44 offen offset:2048 lds
buffer_load_dwordx4 v9, s[12:15], s44 offen offset:3072 lds
s_add_u32 s46, s46, 1
s_cmp_eq_u32 s46, 9
s_cselect_b32 s46, 0, s46
s_add_u32 m0, s68, 32768
s_lshl_b32 s44, s65, 13
s_add_u32 s44, s44, s67
buffer_load_dwordx4 v14, s[60:63], s44 offen offset:0 lds
buffer_load_dwordx4 v14, s[60:63], s44 offen offset:1024 lds
buffer_load_dwordx4 v14, s[60:63], s44 offen offset:2048 lds
buffer_load_dwordx4 v14, s[60:63], s44 offen offset:3072 lds
s_add_u32 m0, s68, 36864
s_lshl_b32 s44, s65, 13
s_add_u32 s44, s44, s67
s_add_u32 s44, s44, 4096
buffer_load_dwordx4 v14, s[60:63], s44 offen offset:0 lds
buffer_load_dwordx4 v14, s[60:63], s44 offen offset:1024 lds
buffer_load_dwordx4 v14, s[60:63], s44 offen offset:2048 lds
buffer_load_dwordx4 v14, s[60:63], s44 offen offset:3072 lds
s_waitcnt vmcnt(12)
s_barrier
s_waitcnt vmcnt(8)
s_barrier
s_barrier
s_add_u32 m0, s42, 0
s_mul_i32 s44, s64, 147456
buffer_load_dwordx4 v15, s[56:59], s44 offen offset:0 lds
buffer_load_dwordx4 v16, s[56:59], s44 offen offset:1024 lds
buffer_load_dwordx4 v17, s[56:59], s44 offen offset:2048 lds
buffer_load_dwordx4 v18, s[56:59], s44 offen offset:3072 lds
s_add_u32 m0, s42, 65536
s_mul_i32 s44, s64, 147456
buffer_load_dwordx4 v48, s[56:59], s44 offen offset:0 lds
buffer_load_dwordx4 v49, s[56:59], s44 offen offset:1024 lds
buffer_load_dwordx4 v50, s[56:59], s44 offen offset:2048 lds
buffer_load_dwordx4 v51, s[56:59], s44 offen offset:3072 lds
s_add_u32 m0, s42, 16384
s_mul_i32 s44, s64, 147456
s_add_u32 s44, s44, 73728
buffer_load_dwordx4 v15, s[56:59], s44 offen offset:0 lds
buffer_load_dwordx4 v16, s[56:59], s44 offen offset:1024 lds
buffer_load_dwordx4 v17, s[56:59], s44 offen offset:2048 lds
buffer_load_dwordx4 v18, s[56:59], s44 offen offset:3072 lds
s_waitcnt vmcnt(4)
s_barrier
L_ph2:
s_add_u32 m0, s42, 32768
s_mul_i32 s44, s65, 147456
buffer_load_dwordx4 v15, s[56:59], s44 offen offset:0 lds
buffer_load_dwordx4 v16, s[56:59], s44 offen offset:1024 lds
buffer_load_dwordx4 v17, s[56:59], s44 offen offset:2048 lds
buffer_load_dwordx4 v18, s[56:59], s44 offen offset:3072 lds
s_add_u32 m0, s42, 49152
s_mul_i32 s44, s65, 147456
s_add_u32 s44, s44, 73728
buffer_load_dwordx4 v15, s[56:59], s44 offen offset:0 lds
buffer_load_dwordx4 v16, s[56:59], s44 offen offset:1024 lds
buffer_load_dwordx4 v17, s[56:59], s44 offen offset:2048 lds
buffer_load_dwordx4 v18, s[56:59], s44 offen offset:3072 lds
v_and_b32 v26, 31, v0
v_mul_u32_u24 v26, 1152, v26
v_lshrrev_b32 v27, 5, v0
v_lshl_add_u32 v27, v27, 7, v26
s_mul_i32 s44, s82, 147456
s_mul_i32 s45, s41, 36864
s_add_u32 s44, s44, s45
buffer_load_dword v28, v27, s[56:59], s44 offen
s_waitcnt vmcnt(9)
s_barrier
s_add_u32 m0, s68, 0
s_lshl_b32 s44, s82, 13
s_add_u32 s44, s44, s67
buffer_load_dwordx4 v14, s[60:63], s44 offen offset:0 lds
buffer_load_dwordx4 v14, s[60:63], s44 offen offset:1024 lds
buffer_load_dwordx4 v14, s[60:63], s44 offen offset:2048 lds
buffer_load_dwordx4 v14, s[60:63], s44 offen offset:3072 lds
s_add_u32 m0, s68, 4096
s_lshl_b32 s44, s82, 13
s_add_u32 s44, s44, s67
s_add_u32 s44, s44, 4096
buffer_load_dwordx4 v14, s[60:63], s44 offen offset:0 lds
buffer_load_dwordx4 v14, s[60:63], s44 offen offset:1024 lds
buffer_load_dwordx4 v14, s[60:63], s44 offen offset:2048 lds
buffer_load_dwordx4 v14, s[60:63], s44 offen offset:3072 lds
s_waitcnt vmcnt(13)
s_barrier
s_add_u32 m0, s42, 65536
s_mul_i32 s44, s65, 147456
buffer_load_dwordx4 v48, s[56:59], s44 offen offset:0 lds
buffer_load_dwordx4 v49, s[56:59], s44 offen offset:1024 lds
buffer_load_dwordx4 v50, s[56:59], s44 offen offset:2048 lds
buffer_load_dwordx4 v51, s[56:59], s44 offen offset:3072 lds
s_add_u32 m0, s42, 0
s_mul_i32 s44, s82, 147456
buffer_load_dwordx4 v15, s[56:59], s44 offen offset:0 lds
buffer_load_dwordx4 v16, s[56:59], s44 offen offset:1024 lds
buffer_load_dwordx4 v17, s[56:59], s44 offen offset:2048 lds
buffer_load_dwordx4 v18, s[56:59], s44 offen offset:3072 lds
s_add_u32 m0, s68, 32768
s_lshl_b32 s44, s83, 13
s_add_u32 s44, s44, s67
buffer_load_dwordx4 v14, s[60:63], s44 offen offset:0 lds
buffer_load_dwordx4 v14, s[60:63], s44 offen offset:1024 lds
buffer_load_dwordx4 v14, s[60:63], s44 offen offset:2048 lds
buffer_load_dwordx4 v14, s[60:63], s44 offen offset:3072 lds
s_waitcnt vmcnt(8)
s_barrier
s_add_u32 m0, s70, 0
s_lshl_b32 s44, s82, 11
s_add_u32 s44, s44, s71
buffer_load_dwordx4 v20, s[20:23], s44 offen offset:0 sc1 lds
buffer_load_dwordx4 v20, s[20:23], s44 offen offset:1024 sc1 lds
s_mov_b32 s89, 0
s_waitcnt vmcnt(0)
L_vf2:
ds_read_b128 v[40:43], v25 offset:0
ds_read_b128 v[44:47], v25 offset:1024
s_add_u32 s89, s89, 1
s_waitcnt lgkmcnt(0)
v_xor_b32 v40, v40, v32
v_xor_b32 v41, v41, v33
v_xor_b32 v42, v42, v34
v_xor_b32 v43, v43, v35
v_xor_b32 v44, v44, v32
v_xor_b32 v45, v45, v33
v_xor_b32 v46, v46, v34
v_xor_b32 v47, v47, v35
v_or3_b32 v40, v40, v41, v42
v_or3_b32 v43, v43, v44, v45
v_or3_b32 v40, v40, v46, v47
v_or_b32 v40, v40, v43
v_and_b32 v40, s43, v40
v_cmp_ne_u32 vcc, 0, v40
s_cbranch_vccz L_vf2x
s_add_u32 m0, s70, 0
s_lshl_b32 s44, s82, 11
s_add_u32 s44, s44, s71
buffer_load_dwordx4 v20, s[20:23], s44 offen offset:0 sc1 lds
buffer_load_dwordx4 v20, s[20:23], s44 offen offset:1024 sc1 lds
s_waitcnt vmcnt(0)
s_cmp_lt_u32 s89, 262144
s_cbranch_scc1 L_vf2
L_vf2x:
s_waitcnt vmcnt(14)
s_barrier
s_add_u32 m0, s42, 16384
s_mul_i32 s44, s82, 147456
s_add_u32 s44, s44, 73728
buffer_load_dwordx4 v15, s[56:59], s44 offen offset:0 lds
buffer_load_dwordx4 v16, s[56:59], s44 offen offset:1024 lds
buffer_load_dwordx4 v17, s[56:59], s44 offen offset:2048 lds
buffer_load_dwordx4 v18, s[56:59], s44 offen offset:3072 lds
s_add_u32 m0, s70, 8192
s_lshl_b32 s44, s83, 11
s_add_u32 s44, s44, s71
buffer_load_dwordx4 v20, s[20:23], s44 offen offset:0 sc1 lds
buffer_load_dwordx4 v20, s[20:23], s44 offen offset:1024 sc1 lds
s_add_u32 m0, s68, 36864
s_lshl_b32 s44, s83, 13
s_add_u32 s44, s44, s67
s_add_u32 s44, s44, 4096
buffer_load_dwordx4 v14, s[60:63], s44 offen offset:0 lds
buffer_load_dwordx4 v14, s[60:63], s44 offen offset:1024 lds
buffer_load_dwordx4 v14, s[60:63], s44 offen offset:2048 lds
buffer_load_dwordx4 v14, s[60:63], s44 offen offset:3072 lds
s_waitcnt vmcnt(16)
s_barrier
s_add_u32 m0, s42, 32768
s_mul_i32 s44, s83, 147456
buffer_load_dwordx4 v15, s[56:59], s44 offen offset:0 lds
buffer_load_dwordx4 v16, s[56:59], s44 offen offset:1024 lds
buffer_load_dwordx4 v17, s[56:59], s44 offen offset:2048 lds
buffer_load_dwordx4 v18, s[56:59], s44 offen offset:3072 lds
s_add_u32 m0, s70, 0
s_lshl_b32 s44, s84, 11
s_add_u32 s44, s44, s71
buffer_load_dwordx4 v20, s[20:23], s44 offen offset:0 sc1 lds
buffer_load_dwordx4 v20, s[20:23], s44 offen offset:1024 sc1 lds
s_add_u32 m0, s68, 0
s_lshl_b32 s44, s84, 13
s_add_u32 s44, s44, s67
buffer_load_dwordx4 v14, s[60:63], s44 offen offset:0 lds
buffer_load_dwordx4 v14, s[60:63], s44 offen offset:1024 lds
buffer_load_dwordx4 v14, s[60:63], s44 offen offset:2048 lds
buffer_load_dwordx4 v14, s[60:63], s44 offen offset:3072 lds
s_mov_b32 s89, 0
s_waitcnt vmcnt(14)
L_vf3:
ds_read_b128 v[40:43], v25 offset:8192
ds_read_b128 v[44:47], v25 offset:9216
s_add_u32 s89, s89, 1
s_waitcnt lgkmcnt(0)
v_xor_b32 v40, v40, v32
v_xor_b32 v41, v41, v33
v_xor_b32 v42, v42, v34
v_xor_b32 v43, v43, v35
v_xor_b32 v44, v44, v32
v_xor_b32 v45, v45, v33
v_xor_b32 v46, v46, v34
v_xor_b32 v47, v47, v35
v_or3_b32 v40, v40, v41, v42
v_or3_b32 v43, v43, v44, v45
v_or3_b32 v40, v40, v46, v47
v_or_b32 v40, v40, v43
v_and_b32 v40, s43, v40
v_cmp_ne_u32 vcc, 0, v40
s_cbranch_vccz L_vf3x
s_add_u32 m0, s70, 8192
s_lshl_b32 s44, s83, 11
s_add_u32 s44, s44, s71
buffer_load_dwordx4 v20, s[20:23], s44 offen offset:0 sc1 lds
buffer_load_dwordx4 v20, s[20:23], s44 offen offset:1024 sc1 lds
s_waitcnt vmcnt(0)
s_cmp_lt_u32 s89, 262144
s_cbranch_scc1 L_vf3
L_vf3x:
s_waitcnt vmcnt(10)
s_barrier
s_add_u32 m0, s42, 49152
s_mul_i32 s44, s83, 147456
s_add_u32 s44, s44, 73728
buffer_load_dwordx4 v15, s[56:59], s44 offen offset:0 lds
buffer_load_dwordx4 v16, s[56:59], s44 offen offset:1024 lds
buffer_load_dwordx4 v17, s[56:59], s44 offen offset:2048 lds
buffer_load_dwordx4 v18, s[56:59], s44 offen offset:3072 lds
s_add_u32 m0, s68, 4096
s_lshl_b32 s44, s84, 13
s_add_u32 s44, s44, s67
s_add_u32 s44, s44, 4096
buffer_load_dwordx4 v14, s[60:63], s44 offen offset:0 lds
buffer_load_dwordx4 v14, s[60:63], s44 offen offset:1024 lds
buffer_load_dwordx4 v14, s[60:63], s44 offen offset:2048 lds
buffer_load_dwordx4 v14, s[60:63], s44 offen offset:3072 lds
s_mov_b32 s89, 0
s_waitcnt vmcnt(12)
L_vf4:
ds_read_b128 v[40:43], v25 offset:0
ds_read_b128 v[44:47], v25 offset:1024
s_add_u32 s89, s89, 1
s_waitcnt lgkmcnt(0)
v_xor_b32 v40, v40, v32
v_xor_b32 v41, v41, v33
v_xor_b32 v42, v42, v34
v_xor_b32 v43, v43, v35
v_xor_b32 v44, v44, v32
v_xor_b32 v45, v45, v33
v_xor_b32 v46, v46, v34
v_xor_b32 v47, v47, v35
v_or3_b32 v40, v40, v41, v42
v_or3_b32 v43, v43, v44, v45
v_or3_b32 v40, v40, v46, v47
v_or_b32 v40, v40, v43
v_and_b32 v40, s43, v40
v_cmp_ne_u32 vcc, 0, v40
s_cbranch_vccz L_vf4x
s_add_u32 m0, s70, 0
s_lshl_b32 s44, s84, 11
s_add_u32 s44, s44, s71
buffer_load_dwordx4 v20, s[20:23], s44 offen offset:0 sc1 lds
buffer_load_dwordx4 v20, s[20:23], s44 offen offset:1024 sc1 lds
s_waitcnt vmcnt(0)
s_cmp_lt_u32 s89, 262144
s_cbranch_scc1 L_vf4
L_vf4x:
s_waitcnt vmcnt(14)
s_barrier
s_add_u32 m0, s42, 0
s_mul_i32 s44, s84, 147456
buffer_load_dwordx4 v15, s[56:59], s44 offen offset:0 lds
buffer_load_dwordx4 v16, s[56:59], s44 offen offset:1024 lds
buffer_load_dwordx4 v17, s[56:59], s44 offen offset:2048 lds
buffer_load_dwordx4 v18, s[56:59], s44 offen offset:3072 lds
s_add_u32 m0, s70, 8192
s_lshl_b32 s44, s85, 11
s_add_u32 s44, s44, s71
buffer_load_dwordx4 v20, s[20:23], s44 offen offset:0 sc1 lds
buffer_load_dwordx4 v20, s[20:23], s44 offen offset:1024 sc1 lds
s_add_u32 m0, s68, 32768
s_lshl_b32 s44, s85, 13
s_add_u32 s44, s44, s67
buffer_load_dwordx4 v14, s[60:63], s44 offen offset:0 lds
buffer_load_dwordx4 v14, s[60:63], s44 offen offset:1024 lds
buffer_load_dwordx4 v14, s[60:63], s44 offen offset:2048 lds
buffer_load_dwordx4 v14, s[60:63], s44 offen offset:3072 lds
s_waitcnt vmcnt(10)
s_barrier
s_add_u32 m0, s42, 16384
s_mul_i32 s44, s84, 147456
s_add_u32 s44, s44, 73728
buffer_load_dwordx4 v15, s[56:59], s44 offen offset:0 lds
buffer_load_dwordx4 v16, s[56:59], s44 offen offset:1024 lds
buffer_load_dwordx4 v17, s[56:59], s44 offen offset:2048 lds
buffer_load_dwordx4 v18, s[56:59], s44 offen offset:3072 lds
s_add_u32 m0, s68, 36864
s_lshl_b32 s44, s85, 13
s_add_u32 s44, s44, s67
s_add_u32 s44, s44, 4096
buffer_load_dwordx4 v14, s[60:63], s44 offen offset:0 lds
buffer_load_dwordx4 v14, s[60:63], s44 offen offset:1024 lds
buffer_load_dwordx4 v14, s[60:63], s44 offen offset:2048 lds
buffer_load_dwordx4 v14, s[60:63], s44 offen offset:3072 lds
s_mov_b32 s89, 0
s_waitcnt vmcnt(12)
L_vf5:
ds_read_b128 v[40:43], v25 offset:8192
ds_read_b128 v[44:47], v25 offset:9216
s_add_u32 s89, s89, 1
s_waitcnt lgkmcnt(0)
v_xor_b32 v40, v40, v32
v_xor_b32 v41, v41, v33
v_xor_b32 v42, v42, v34
v_xor_b32 v43, v43, v35
v_xor_b32 v44, v44, v32
v_xor_b32 v45, v45, v33
v_xor_b32 v46, v46, v34
v_xor_b32 v47, v47, v35
v_or3_b32 v40, v40, v41, v42
v_or3_b32 v43, v43, v44, v45
v_or3_b32 v40, v40, v46, v47
v_or_b32 v40, v40, v43
v_and_b32 v40, s43, v40
v_cmp_ne_u32 vcc, 0, v40
s_cbranch_vccz L_vf5x
s_add_u32 m0, s70, 8192
s_lshl_b32 s44, s85, 11
s_add_u32 s44, s44, s71
buffer_load_dwordx4 v20, s[20:23], s44 offen offset:0 sc1 lds
buffer_load_dwordx4 v20, s[20:23], s44 offen offset:1024 sc1 lds
s_waitcnt vmcnt(0)
s_cmp_lt_u32 s89, 262144
s_cbranch_scc1 L_vf5
L_vf5x:
s_waitcnt vmcnt(14)
s_barrier
s_add_u32 m0, s42, 32768
s_mul_i32 s44, s85, 147456
buffer_load_dwordx4 v15, s[56:59], s44 offen offset:0 lds
buffer_load_dwordx4 v16, s[56:59], s44 offen offset:1024 lds
buffer_load_dwordx4 v17, s[56:59], s44 offen offset:2048 lds
buffer_load_dwordx4 v18, s[56:59], s44 offen offset:3072 lds
s_add_u32 m0, s70, 0
s_lshl_b32 s44, s86, 11
s_add_u32 s44, s44, s71
buffer_load_dwordx4 v20, s[20:23], s44 offen offset:0 sc1 lds
buffer_load_dwordx4 v20, s[20:23], s44 offen offset:1024 sc1 lds
s_add_u32 m0, s68, 0
s_lshl_b32 s44, s86, 13
s_add_u32 s44, s44, s67
buffer_load_dwordx4 v14, s[60:63], s44 offen offset:0 lds
buffer_load_dwordx4 v14, s[60:63], s44 offen offset:1024 lds
buffer_load_dwordx4 v14, s[60:63], s44 offen offset:2048 lds
buffer_load_dwordx4 v14, s[60:63], s44 offen offset:3072 lds
s_waitcnt vmcnt(10)
s_barrier
s_add_u32 m0, s42, 49152
s_mul_i32 s44, s85, 147456
s_add_u32 s44, s44, 73728
buffer_load_dwordx4 v15, s[56:59], s44 offen offset:0 lds
buffer_load_dwordx4 v16, s[56:59], s44 offen offset:1024 lds
buffer_load_dwordx4 v17, s[56:59], s44 offen offset:2048 lds
buffer_load_dwordx4 v18, s[56:59], s44 offen offset:3072 lds
s_add_u32 m0, s68, 4096
s_lshl_b32 s44, s86, 13
s_add_u32 s44, s44, s67
s_add_u32 s44, s44, 4096
buffer_load_dwordx4 v14, s[60:63], s44 offen offset:0 lds
buffer_load_dwordx4 v14, s[60:63], s44 offen offset:1024 lds
buffer_load_dwordx4 v14, s[60:63], s44 offen offset:2048 lds
buffer_load_dwordx4 v14, s[60:63], s44 offen offset:3072 lds
s_mov_b32 s89, 0
s_waitcnt vmcnt(12)
L_vf6:
ds_read_b128 v[40:43], v25 offset:0
ds_read_b128 v[44:47], v25 offset:1024
s_add_u32 s89, s89, 1
s_waitcnt lgkmcnt(0)
v_xor_b32 v40, v40, v32
v_xor_b32 v41, v41, v33
v_xor_b32 v42, v42, v34
v_xor_b32 v43, v43, v35
v_xor_b32 v44, v44, v32
v_xor_b32 v45, v45, v33
v_xor_b32 v46, v46, v34
v_xor_b32 v47, v47, v35
v_or3_b32 v40, v40, v41, v42
v_or3_b32 v43, v43, v44, v45
v_or3_b32 v40, v40, v46, v47
v_or_b32 v40, v40, v43
v_and_b32 v40, s43, v40
v_cmp_ne_u32 vcc, 0, v40
s_cbranch_vccz L_vf6x
s_add_u32 m0, s70, 0
s_lshl_b32 s44, s86, 11
s_add_u32 s44, s44, s71
buffer_load_dwordx4 v20, s[20:23], s44 offen offset:0 sc1 lds
buffer_load_dwordx4 v20, s[20:23], s44 offen offset:1024 sc1 lds
s_waitcnt vmcnt(0)
s_cmp_lt_u32 s89, 262144
s_cbranch_scc1 L_vf6
L_vf6x:
s_waitcnt vmcnt(14)
s_barrier
s_add_u32 m0, s42, 0
s_mul_i32 s44, s86, 147456
buffer_load_dwordx4 v15, s[56:59], s44 offen offset:0 lds
buffer_load_dwordx4 v16, s[56:59], s44 offen offset:1024 lds
buffer_load_dwordx4 v17, s[56:59], s44 offen offset:2048 lds
buffer_load_dwordx4 v18, s[56:59], s44 offen offset:3072 lds
s_add_u32 m0, s70, 8192
s_lshl_b32 s44, s87, 11
s_add_u32 s44, s44, s71
buffer_load_dwordx4 v20, s[20:23], s44 offen offset:0 sc1 lds
buffer_load_dwordx4 v20, s[20:23], s44 offen offset:1024 sc1 lds
s_add_u32 m0, s68, 32768
s_lshl_b32 s44, s87, 13
s_add_u32 s44, s44, s67
buffer_load_dwordx4 v14, s[60:63], s44 offen offset:0 lds
buffer_load_dwordx4 v14, s[60:63], s44 offen offset:1024 lds
buffer_load_dwordx4 v14, s[60:63], s44 offen offset:2048 lds
buffer_load_dwordx4 v14, s[60:63], s44 offen offset:3072 lds
s_waitcnt vmcnt(10)
s_barrier
s_add_u32 m0, s42, 16384
s_mul_i32 s44, s86, 147456
s_add_u32 s44, s44, 73728
buffer_load_dwordx4 v15, s[56:59], s44 offen offset:0 lds
buffer_load_dwordx4 v16, s[56:59], s44 offen offset:1024 lds
buffer_load_dwordx4 v17, s[56:59], s44 offen offset:2048 lds
buffer_load_dwordx4 v18, s[56:59], s44 offen offset:3072 lds
s_add_u32 m0, s68, 36864
s_lshl_b32 s44, s87, 13
s_add_u32 s44, s44, s67
s_add_u32 s44, s44, 4096
buffer_load_dwordx4 v14, s[60:63], s44 offen offset:0 lds
buffer_load_dwordx4 v14, s[60:63], s44 offen offset:1024 lds
buffer_load_dwordx4 v14, s[60:63], s44 offen offset:2048 lds
buffer_load_dwordx4 v14, s[60:63], s44 offen offset:3072 lds
s_mov_b32 s89, 0
s_waitcnt vmcnt(12)
L_vf7:
ds_read_b128 v[40:43], v25 offset:8192
ds_read_b128 v[44:47], v25 offset:9216
s_add_u32 s89, s89, 1
s_waitcnt lgkmcnt(0)
v_xor_b32 v40, v40, v32
v_xor_b32 v41, v41, v33
v_xor_b32 v42, v42, v34
v_xor_b32 v43, v43, v35
v_xor_b32 v44, v44, v32
v_xor_b32 v45, v45, v33
v_xor_b32 v46, v46, v34
v_xor_b32 v47, v47, v35
v_or3_b32 v40, v40, v41, v42
v_or3_b32 v43, v43, v44, v45
v_or3_b32 v40, v40, v46, v47
v_or_b32 v40, v40, v43
v_and_b32 v40, s43, v40
v_cmp_ne_u32 vcc, 0, v40
s_cbranch_vccz L_vf7x
s_add_u32 m0, s70, 8192
s_lshl_b32 s44, s87, 11
s_add_u32 s44, s44, s71
buffer_load_dwordx4 v20, s[20:23], s44 offen offset:0 sc1 lds
buffer_load_dwordx4 v20, s[20:23], s44 offen offset:1024 sc1 lds
s_waitcnt vmcnt(0)
s_cmp_lt_u32 s89, 262144
s_cbranch_scc1 L_vf7
L_vf7x:
s_waitcnt vmcnt(14)
s_barrier
s_add_u32 m0, s42, 32768
s_mul_i32 s44, s87, 147456
buffer_load_dwordx4 v15, s[56:59], s44 offen offset:0 lds
buffer_load_dwordx4 v16, s[56:59], s44 offen offset:1024 lds
buffer_load_dwordx4 v17, s[56:59], s44 offen offset:2048 lds
buffer_load_dwordx4 v18, s[56:59], s44 offen offset:3072 lds
s_waitcnt vmcnt(4)
s_barrier
s_add_u32 m0, s42, 49152
s_mul_i32 s44, s87, 147456
s_add_u32 s44, s44, 73728
buffer_load_dwordx4 v15, s[56:59], s44 offen offset:0 lds
buffer_load_dwordx4 v16, s[56:59], s44 offen offset:1024 lds
buffer_load_dwordx4 v17, s[56:59], s44 offen offset:2048 lds
buffer_load_dwordx4 v18, s[56:59], s44 offen offset:3072 lds
s_waitcnt vmcnt(4)
s_barrier
s_waitcnt vmcnt(0)
s_barrier
s_cmp_lg_u32 s41, 0
s_cbranch_scc1 L_rx
s_lshl_b32 s44, s5, 3
s_add_u32 s44, s44, s7
s_lshl_b32 s44, s44, 2
s_add_u32 s44, s44, s6
s_lshl_b32 s44, s44, 2
s_add_u32 s44, s44, s24
s_lshl_b32 s44, s44, 14
s_add_u32 s72, s44, 20971520
s_mov_b32 s8, s52
s_mov_b32 s9, s53
s_mov_b32 s10, 2359296
s_mov_b32 s11, 0x20000
s_lshl_b32 s44, s7, 2
s_add_u32 s44, s44, s24
s_mul_i32 s44, s44, 73728
s_mul_i32 s45, s5, 1152
s_add_u32 s44, s44, s45
s_lshl_b32 s45, s6, 5
s_add_u32 s44, s44, s45
s_add_u32 s12, s44, 1024
s_mov_b32 s14, 0xffff0000
s_mov_b32 s15, 0x10001
v_and_b32 v26, 31, v0
v_mul_u32_u24 v26, 2304, v26
v_lshrrev_b32 v27, 5, v0
v_lshl_add_u32 v26, v27, 4, v26
v_mov_b32 v27, 0x8000
s_mov_b32 s89, 0
v_lshrrev_b32 v36, 15, v32
v_lshrrev_b32 v37, 15, v33
v_lshrrev_b32 v38, 15, v34
v_lshrrev_b32 v39, 15, v35
v_readlane_b32 s76, v36, 0
v_readlane_b32 s77, v37, 0
v_readlane_b32 s78, v38, 0
v_readlane_b32 s79, v39, 0
v_lshlrev_b32 v29, 10, v0
s_mov_b64 exec, 0xffff
L_rp:
buffer_load_dwordx4 v[64:67], v29, s[20:23], s72 offen sc1
s_add_u32 s89, s89, 1
s_waitcnt vmcnt(0)
v_xor_b32 v64, s76, v64
v_xor_b32 v65, s77, v65
v_xor_b32 v66, s78, v66
v_xor_b32 v67, s79, v67
v_or3_b32 v64, v64, v65, v66
v_or_b32 v64, v64, v67
v_and_b32 v64, s15, v64
v_cmp_ne_u32 vcc, 0, v64
s_cbranch_vccz L_rpx
s_cmp_lt_u32 s89, 262144
s_cbranch_scc1 L_rp
L_rpx:
s_mov_b64 exec, -1
L_rg:
s_mov_b32 s44, s72
buffer_load_dwordx4 v[64:67], v20, s[20:23], s44 offen offset:0 sc1
buffer_load_dwordx4 v[68:71], v20, s[20:23], s44 offen offset:1024 sc1
buffer_load_dwordx4 v[72:75], v20, s[20:23], s44 offen offset:2048 sc1
buffer_load_dwordx4 v[76:79], v20, s[20:23], s44 offen offset:3072 sc1
s_add_u32 s44, s44, 4096
buffer_load_dwordx4 v[80:83], v20, s[20:23], s44 offen offset:0 sc1
buffer_load_dwordx4 v[84:87], v20, s[20:23], s44 offen offset:1024 sc1
buffer_load_dwordx4 v[88:91], v20, s[20:23], s44 offen offset:2048 sc1
buffer_load_dwordx4 v[92:95], v20, s[20:23], s44 offen offset:3072 sc1
s_add_u32 s44, s44, 4096
buffer_load_dwordx4 v[96:99], v20, s[20:23], s44 offen offset:0 sc1
buffer_load_dwordx4 v[100:103], v20, s[20:23], s44 offen offset:1024 sc1
buffer_load_dwordx4 v[104:107], v20, s[20:23], s44 offen offset:2048 sc1
buffer_load_dwordx4 v[108:111], v20, s[20:23], s44 offen offset:3072 sc1
s_add_u32 s44, s44, 4096
buffer_load_dwordx4 v[112:115], v20, s[20:23], s44 offen offset:0 sc1
buffer_load_dwordx4 v[116:119], v20, s[20:23], s44 offen offset:1024 sc1
buffer_load_dwordx4 v[120:123], v20, s[20:23], s44 offen offset:2048 sc1
buffer_load_dwordx4 v[124:127], v20, s[20:23], s44 offen offset:3072 sc1
s_add_u32 s89, s89, 1
v_mov_b32 v28, 0
v_mov_b32 v40, 0
v_mov_b32 v41, 0
v_mov_b32 v42, 0
v_mov_b32 v43, 0
v_mov_b32 v44, 0
v_mov_b32 v45, 0
v_mov_b32 v46, 0
v_mov_b32 v47, 0
s_waitcnt vmcnt(15)
v_xor_b32 v64, v64, v36
v_lshl_or_b32 v30, v64, 16, v27
v_and_or_b32 v31, v64, s14, v27
v_pk_add_f32 v[40:41], v[40:41], v[30:31]
v_xor_b32 v65, v65, v37
v_lshl_or_b32 v30, v65, 16, v27
v_and_or_b32 v31, v65, s14, v27
v_pk_add_f32 v[42:43], v[42:43], v[30:31]
v_or3_b32 v28, v28, v64, v65
v_xor_b32 v66, v66, v38
v_lshl_or_b32 v30, v66, 16, v27
v_and_or_b32 v31, v66, s14, v27
v_pk_add_f32 v[44:45], v[44:45], v[30:31]
v_xor_b32 v67, v67, v39
v_lshl_or_b32 v30, v67, 16, v27
v_and_or_b32 v31, v67, s14, v27
v_pk_add_f32 v[46:47], v[46:47], v[30:31]
v_or3_b32 v28, v28, v66, v67
s_waitcnt vmcnt(14)
v_xor_b32 v68, v68, v36
v_lshl_or_b32 v30, v68, 16, v27
v_and_or_b32 v31, v68, s14, v27
v_pk_add_f32 v[40:41], v[40:41], v[30:31]
v_xor_b32 v69, v69, v37
v_lshl_or_b32 v30, v69, 16, v27
v_and_or_b32 v31, v69, s14, v27
v_pk_add_f32 v[42:43], v[42:43], v[30:31]
v_or3_b32 v28, v28, v68, v69
v_xor_b32 v70, v70, v38
v_lshl_or_b32 v30, v70, 16, v27
v_and_or_b32 v31, v70, s14, v27
v_pk_add_f32 v[44:45], v[44:45], v[30:31]
v_xor_b32 v71, v71, v39
v_lshl_or_b32 v30, v71, 16, v27
v_and_or_b32 v31, v71, s14, v27
v_pk_add_f32 v[46:47], v[46:47], v[30:31]
v_or3_b32 v28, v28, v70, v71
s_waitcnt vmcnt(13)
v_xor_b32 v72, v72, v36
v_lshl_or_b32 v30, v72, 16, v27
v_and_or_b32 v31, v72, s14, v27
v_pk_add_f32 v[40:41], v[40:41], v[30:31]
v_xor_b32 v73, v73, v37
v_lshl_or_b32 v30, v73, 16, v27
v_and_or_b32 v31, v73, s14, v27
v_pk_add_f32 v[42:43], v[42:43], v[30:31]
v_or3_b32 v28, v28, v72, v73
v_xor_b32 v74, v74, v38
v_lshl_or_b32 v30, v74, 16, v27
v_and_or_b32 v31, v74, s14, v27
v_pk_add_f32 v[44:45], v[44:45], v[30:31]
v_xor_b32 v75, v75, v39
v_lshl_or_b32 v30, v75, 16, v27
v_and_or_b32 v31, v75, s14, v27
v_pk_add_f32 v[46:47], v[46:47], v[30:31]
v_or3_b32 v28, v28, v74, v75
s_waitcnt vmcnt(12)
v_xor_b32 v76, v76, v36
v_lshl_or_b32 v30, v76, 16, v27
v_and_or_b32 v31, v76, s14, v27
v_pk_add_f32 v[40:41], v[40:41], v[30:31]
v_xor_b32 v77, v77, v37
v_lshl_or_b32 v30, v77, 16, v27
v_and_or_b32 v31, v77, s14, v27
v_pk_add_f32 v[42:43], v[42:43], v[30:31]
v_or3_b32 v28, v28, v76, v77
v_xor_b32 v78, v78, v38
v_lshl_or_b32 v30, v78, 16, v27
v_and_or_b32 v31, v78, s14, v27
v_pk_add_f32 v[44:45], v[44:45], v[30:31]
v_xor_b32 v79, v79, v39
v_lshl_or_b32 v30, v79, 16, v27
v_and_or_b32 v31, v79, s14, v27
v_pk_add_f32 v[46:47], v[46:47], v[30:31]
v_or3_b32 v28, v28, v78, v79
s_waitcnt vmcnt(11)
v_xor_b32 v80, v80, v36
v_lshl_or_b32 v30, v80, 16, v27
v_and_or_b32 v31, v80, s14, v27
v_pk_add_f32 v[40:41], v[40:41], v[30:31]
v_xor_b32 v81, v81, v37
v_lshl_or_b32 v30, v81, 16, v27
v_and_or_b32 v31, v81, s14, v27
v_pk_add_f32 v[42:43], v[42:43], v[30:31]
v_or3_b32 v28, v28, v80, v81
v_xor_b32 v82, v82, v38
v_lshl_or_b32 v30, v82, 16, v27
v_and_or_b32 v31, v82, s14, v27
v_pk_add_f32 v[44:45], v[44:45], v[30:31]
v_xor_b32 v83, v83, v39
v_lshl_or_b32 v30, v83, 16, v27
v_and_or_b32 v31, v83, s14, v27
v_pk_add_f32 v[46:47], v[46:47], v[30:31]
v_or3_b32 v28, v28, v82, v83
s_waitcnt vmcnt(10)
v_xor_b32 v84, v84, v36
v_lshl_or_b32 v30, v84, 16, v27
v_and_or_b32 v31, v84, s14, v27
v_pk_add_f32 v[40:41], v[40:41], v[30:31]
v_xor_b32 v85, v85, v37
v_lshl_or_b32 v30, v85, 16, v27
v_and_or_b32 v31, v85, s14, v27
v_pk_add_f32 v[42:43], v[42:43], v[30:31]
v_or3_b32 v28, v28, v84, v85
v_xor_b32 v86, v86, v38
v_lshl_or_b32 v30, v86, 16, v27
v_and_or_b32 v31, v86, s14, v27
v_pk_add_f32 v[44:45], v[44:45], v[30:31]
v_xor_b32 v87, v87, v39
v_lshl_or_b32 v30, v87, 16, v27
v_and_or_b32 v31, v87, s14, v27
v_pk_add_f32 v[46:47], v[46:47], v[30:31]
v_or3_b32 v28, v28, v86, v87
s_waitcnt vmcnt(9)
v_xor_b32 v88, v88, v36
v_lshl_or_b32 v30, v88, 16, v27
v_and_or_b32 v31, v88, s14, v27
v_pk_add_f32 v[40:41], v[40:41], v[30:31]
v_xor_b32 v89, v89, v37
v_lshl_or_b32 v30, v89, 16, v27
v_and_or_b32 v31, v89, s14, v27
v_pk_add_f32 v[42:43], v[42:43], v[30:31]
v_or3_b32 v28, v28, v88, v89
v_xor_b32 v90, v90, v38
v_lshl_or_b32 v30, v90, 16, v27
v_and_or_b32 v31, v90, s14, v27
v_pk_add_f32 v[44:45], v[44:45], v[30:31]
v_xor_b32 v91, v91, v39
v_lshl_or_b32 v30, v91, 16, v27
v_and_or_b32 v31, v91, s14, v27
v_pk_add_f32 v[46:47], v[46:47], v[30:31]
v_or3_b32 v28, v28, v90, v91
s_waitcnt vmcnt(8)
v_xor_b32 v92, v92, v36
v_lshl_or_b32 v30, v92, 16, v27
v_and_or_b32 v31, v92, s14, v27
v_pk_add_f32 v[40:41], v[40:41], v[30:31]
v_xor_b32 v93, v93, v37
v_lshl_or_b32 v30, v93, 16, v27
v_and_or_b32 v31, v93, s14, v27
v_pk_add_f32 v[42:43], v[42:43], v[30:31]
v_or3_b32 v28, v28, v92, v93
v_xor_b32 v94, v94, v38
v_lshl_or_b32 v30, v94, 16, v27
v_and_or_b32 v31, v94, s14, v27
v_pk_add_f32 v[44:45], v[44:45], v[30:31]
v_xor_b32 v95, v95, v39
v_lshl_or_b32 v30, v95, 16, v27
v_and_or_b32 v31, v95, s14, v27
v_pk_add_f32 v[46:47], v[46:47], v[30:31]
v_or3_b32 v28, v28, v94, v95
s_waitcnt vmcnt(7)
v_xor_b32 v96, v96, v36
v_lshl_or_b32 v30, v96, 16, v27
v_and_or_b32 v31, v96, s14, v27
v_pk_add_f32 v[40:41], v[40:41], v[30:31]
v_xor_b32 v97, v97, v37
v_lshl_or_b32 v30, v97, 16, v27
v_and_or_b32 v31, v97, s14, v27
v_pk_add_f32 v[42:43], v[42:43], v[30:31]
v_or3_b32 v28, v28, v96, v97
v_xor_b32 v98, v98, v38
v_lshl_or_b32 v30, v98, 16, v27
v_and_or_b32 v31, v98, s14, v27
v_pk_add_f32 v[44:45], v[44:45], v[30:31]
v_xor_b32 v99, v99, v39
v_lshl_or_b32 v30, v99, 16, v27
v_and_or_b32 v31, v99, s14, v27
v_pk_add_f32 v[46:47], v[46:47], v[30:31]
v_or3_b32 v28, v28, v98, v99
s_waitcnt vmcnt(6)
v_xor_b32 v100, v100, v36
v_lshl_or_b32 v30, v100, 16, v27
v_and_or_b32 v31, v100, s14, v27
v_pk_add_f32 v[40:41], v[40:41], v[30:31]
v_xor_b32 v101, v101, v37
v_lshl_or_b32 v30, v101, 16, v27
v_and_or_b32 v31, v101, s14, v27
v_pk_add_f32 v[42:43], v[42:43], v[30:31]
v_or3_b32 v28, v28, v100, v101
v_xor_b32 v102, v102, v38
v_lshl_or_b32 v30, v102, 16, v27
v_and_or_b32 v31, v102, s14, v27
v_pk_add_f32 v[44:45], v[44:45], v[30:31]
v_xor_b32 v103, v103, v39
v_lshl_or_b32 v30, v103, 16, v27
v_and_or_b32 v31, v103, s14, v27
v_pk_add_f32 v[46:47], v[46:47], v[30:31]
v_or3_b32 v28, v28, v102, v103
s_waitcnt vmcnt(5)
v_xor_b32 v104, v104, v36
v_lshl_or_b32 v30, v104, 16, v27
v_and_or_b32 v31, v104, s14, v27
v_pk_add_f32 v[40:41], v[40:41], v[30:31]
v_xor_b32 v105, v105, v37
v_lshl_or_b32 v30, v105, 16, v27
v_and_or_b32 v31, v105, s14, v27
v_pk_add_f32 v[42:43], v[42:43], v[30:31]
v_or3_b32 v28, v28, v104, v105
v_xor_b32 v106, v106, v38
v_lshl_or_b32 v30, v106, 16, v27
v_and_or_b32 v31, v106, s14, v27
v_pk_add_f32 v[44:45], v[44:45], v[30:31]
v_xor_b32 v107, v107, v39
v_lshl_or_b32 v30, v107, 16, v27
v_and_or_b32 v31, v107, s14, v27
v_pk_add_f32 v[46:47], v[46:47], v[30:31]
v_or3_b32 v28, v28, v106, v107
s_waitcnt vmcnt(4)
v_xor_b32 v108, v108, v36
v_lshl_or_b32 v30, v108, 16, v27
v_and_or_b32 v31, v108, s14, v27
v_pk_add_f32 v[40:41], v[40:41], v[30:31]
v_xor_b32 v109, v109, v37
v_lshl_or_b32 v30, v109, 16, v27
v_and_or_b32 v31, v109, s14, v27
v_pk_add_f32 v[42:43], v[42:43], v[30:31]
v_or3_b32 v28, v28, v108, v109
v_xor_b32 v110, v110, v38
v_lshl_or_b32 v30, v110, 16, v27
v_and_or_b32 v31, v110, s14, v27
v_pk_add_f32 v[44:45], v[44:45], v[30:31]
v_xor_b32 v111, v111, v39
v_lshl_or_b32 v30, v111, 16, v27
v_and_or_b32 v31, v111, s14, v27
v_pk_add_f32 v[46:47], v[46:47], v[30:31]
v_or3_b32 v28, v28, v110, v111
s_waitcnt vmcnt(3)
v_xor_b32 v112, v112, v36
v_lshl_or_b32 v30, v112, 16, v27
v_and_or_b32 v31, v112, s14, v27
v_pk_add_f32 v[40:41], v[40:41], v[30:31]
v_xor_b32 v113, v113, v37
v_lshl_or_b32 v30, v113, 16, v27
v_and_or_b32 v31, v113, s14, v27
v_pk_add_f32 v[42:43], v[42:43], v[30:31]
v_or3_b32 v28, v28, v112, v113
v_xor_b32 v114, v114, v38
v_lshl_or_b32 v30, v114, 16, v27
v_and_or_b32 v31, v114, s14, v27
v_pk_add_f32 v[44:45], v[44:45], v[30:31]
v_xor_b32 v115, v115, v39
v_lshl_or_b32 v30, v115, 16, v27
v_and_or_b32 v31, v115, s14, v27
v_pk_add_f32 v[46:47], v[46:47], v[30:31]
v_or3_b32 v28, v28, v114, v115
s_waitcnt vmcnt(2)
v_xor_b32 v116, v116, v36
v_lshl_or_b32 v30, v116, 16, v27
v_and_or_b32 v31, v116, s14, v27
v_pk_add_f32 v[40:41], v[40:41], v[30:31]
v_xor_b32 v117, v117, v37
v_lshl_or_b32 v30, v117, 16, v27
v_and_or_b32 v31, v117, s14, v27
v_pk_add_f32 v[42:43], v[42:43], v[30:31]
v_or3_b32 v28, v28, v116, v117
v_xor_b32 v118, v118, v38
v_lshl_or_b32 v30, v118, 16, v27
v_and_or_b32 v31, v118, s14, v27
v_pk_add_f32 v[44:45], v[44:45], v[30:31]
v_xor_b32 v119, v119, v39
v_lshl_or_b32 v30, v119, 16, v27
v_and_or_b32 v31, v119, s14, v27
v_pk_add_f32 v[46:47], v[46:47], v[30:31]
v_or3_b32 v28, v28, v118, v119
s_waitcnt vmcnt(1)
v_xor_b32 v120, v120, v36
v_lshl_or_b32 v30, v120, 16, v27
v_and_or_b32 v31, v120, s14, v27
v_pk_add_f32 v[40:41], v[40:41], v[30:31]
v_xor_b32 v121, v121, v37
v_lshl_or_b32 v30, v121, 16, v27
v_and_or_b32 v31, v121, s14, v27
v_pk_add_f32 v[42:43], v[42:43], v[30:31]
v_or3_b32 v28, v28, v120, v121
v_xor_b32 v122, v122, v38
v_lshl_or_b32 v30, v122, 16, v27
v_and_or_b32 v31, v122, s14, v27
v_pk_add_f32 v[44:45], v[44:45], v[30:31]
v_xor_b32 v123, v123, v39
v_lshl_or_b32 v30, v123, 16, v27
v_and_or_b32 v31, v123, s14, v27
v_pk_add_f32 v[46:47], v[46:47], v[30:31]
v_or3_b32 v28, v28, v122, v123
s_waitcnt vmcnt(0)
v_xor_b32 v124, v124, v36
v_lshl_or_b32 v30, v124, 16, v27
v_and_or_b32 v31, v124, s14, v27
v_pk_add_f32 v[40:41], v[40:41], v[30:31]
v_xor_b32 v125, v125, v37
v_lshl_or_b32 v30, v125, 16, v27
v_and_or_b32 v31, v125, s14, v27
v_pk_add_f32 v[42:43], v[42:43], v[30:31]
v_or3_b32 v28, v28, v124, v125
v_xor_b32 v126, v126, v38
v_lshl_or_b32 v30, v126, 16, v27
v_and_or_b32 v31, v126, s14, v27
v_pk_add_f32 v[44:45], v[44:45], v[30:31]
v_xor_b32 v127, v127, v39
v_lshl_or_b32 v30, v127, 16, v27
v_and_or_b32 v31, v127, s14, v27
v_pk_add_f32 v[46:47], v[46:47], v[30:31]
v_or3_b32 v28, v28, v126, v127
v_and_b32 v28, s15, v28
v_cmp_ne_u32 vcc, 0, v28
s_cbranch_vccz L_rgx
s_cmp_lt_u32 s89, 262144
s_cbranch_scc1 L_rg
L_rgx:
v_cvt_pk_bf16_f32 v40, v40, v41
v_cvt_pk_bf16_f32 v41, v42, v43
v_cvt_pk_bf16_f32 v42, v44, v45
v_cvt_pk_bf16_f32 v43, v46, v47
s_nop 1
v_permlane32_swap_b32 v40, v42
v_permlane32_swap_b32 v41, v43
buffer_store_dwordx4 v[40:43], v26, s[8:11], s12 offen
s_and_b32 s44, s2, 0x1b
s_cbranch_scc1 L_rx
v_mov_b32 v28, s51
s_mov_b64 exec, 1
buffer_store_dword v28, v21, s[20:23], s88 offen sc1
L_rx:
L_end:
s_endpgm
L_cons:
v_mov_b32 v8, 0
v_mov_b32 v9, 0
v_mov_b32 v10, 0
v_mov_b32 v11, 0
v_mov_b32 v12, 0
v_mov_b32 v13, 0
v_mov_b32 v14, 0
v_mov_b32 v15, 0
v_mov_b32 v16, 0
v_mov_b32 v17, 0
v_mov_b32 v18, 0
v_mov_b32 v19, 0
v_mov_b32 v20, 0
v_mov_b32 v21, 0
v_mov_b32 v22, 0
v_mov_b32 v23, 0
v_mov_b32 v24, 0
v_mov_b32 v25, 0
v_mov_b32 v26, 0
v_mov_b32 v27, 0
v_mov_b32 v28, 0
v_mov_b32 v29, 0
v_mov_b32 v30, 0
v_mov_b32 v31, 0
v_mov_b32 v32, 0
v_mov_b32 v33, 0
v_mov_b32 v34, 0
v_mov_b32 v35, 0
v_mov_b32 v36, 0
v_mov_b32 v37, 0
v_mov_b32 v38, 0
v_mov_b32 v39, 0
v_mov_b32 v40, 0
v_mov_b32 v41, 0
v_mov_b32 v42, 0
v_mov_b32 v43, 0
v_mov_b32 v44, 0
v_mov_b32 v45, 0
v_mov_b32 v46, 0
v_mov_b32 v47, 0
v_mov_b32 v48, 0
v_mov_b32 v49, 0
v_mov_b32 v50, 0
v_mov_b32 v51, 0
v_mov_b32 v52, 0
v_mov_b32 v53, 0
v_mov_b32 v54, 0
v_mov_b32 v55, 0
v_mov_b32 v56, 0
v_mov_b32 v57, 0
v_mov_b32 v58, 0
v_mov_b32 v59, 0
v_mov_b32 v60, 0
v_mov_b32 v61, 0
v_mov_b32 v62, 0
v_mov_b32 v63, 0
v_mov_b32 v64, 0
v_mov_b32 v65, 0
v_mov_b32 v66, 0
v_mov_b32 v67, 0
v_mov_b32 v68, 0
v_mov_b32 v69, 0
v_mov_b32 v70, 0
v_mov_b32 v71, 0
v_mov_b32 v72, 0
v_mov_b32 v73, 0
v_mov_b32 v74, 0
v_mov_b32 v75, 0
v_mov_b32 v76, 0
v_mov_b32 v77, 0
v_mov_b32 v78, 0
v_mov_b32 v79, 0
v_mov_b32 v80, 0
v_mov_b32 v81, 0
v_mov_b32 v82, 0
v_mov_b32 v83, 0
v_mov_b32 v84, 0
v_mov_b32 v85, 0
v_mov_b32 v86, 0
v_mov_b32 v87, 0
v_mov_b32 v88, 0
v_mov_b32 v89, 0
v_mov_b32 v90, 0
v_mov_b32 v91, 0
v_mov_b32 v92, 0
v_mov_b32 v93, 0
v_mov_b32 v94, 0
v_mov_b32 v95, 0
v_mov_b32 v96, 0
v_mov_b32 v97, 0
v_mov_b32 v98, 0
v_mov_b32 v99, 0
v_mov_b32 v100, 0
v_mov_b32 v101, 0
v_mov_b32 v102, 0
v_mov_b32 v103, 0
v_mov_b32 v104, 0
v_mov_b32 v105, 0
v_mov_b32 v106, 0
v_mov_b32 v107, 0
v_mov_b32 v108, 0
v_mov_b32 v109, 0
v_mov_b32 v110, 0
v_mov_b32 v111, 0
v_mov_b32 v112, 0
v_mov_b32 v113, 0
v_mov_b32 v114, 0
v_mov_b32 v115, 0
v_mov_b32 v116, 0
v_mov_b32 v117, 0
v_mov_b32 v118, 0
v_mov_b32 v119, 0
v_mov_b32 v120, 0
v_mov_b32 v121, 0
v_mov_b32 v122, 0
v_mov_b32 v123, 0
v_mov_b32 v124, 0
v_mov_b32 v125, 0
v_mov_b32 v126, 0
v_mov_b32 v127, 0
s_and_b32 s41, s40, 1
s_lshr_b32 s42, s40, 1
v_lshrrev_b32 v1, 4, v0
v_bfe_u32 v2, v0, 2, 2
v_and_b32 v3, 3, v0
v_and_b32 v4, 1, v1
v_lshl_add_u32 v5, v1, 3, v2
v_lshlrev_b32 v5, 9, v5
v_lshl_add_u32 v5, v2, 6, v5
v_lshl_add_u32 v5, v4, 5, v5
v_lshl_add_u32 v5, v3, 3, v5
s_lshl_b32 s44, s42, 8
s_add_u32 s44, s44, 32768
v_add_u32 v240, s44, v5
v_xor_b32 v241, 32, v240
v_xor_b32 v242, 64, v240
v_xor_b32 v243, 96, v240
v_xor_b32 v244, 128, v240
v_xor_b32 v245, 160, v240
v_xor_b32 v246, 192, v240
v_xor_b32 v247, 224, v240
v_and_b32 v2, 15, v0
v_bfe_u32 v3, v0, 1, 3
v_xor_b32 v3, v3, v1
v_lshlrev_b32 v3, 4, v3
v_lshl_add_u32 v3, v2, 7, v3
s_lshl_b32 s44, s41, 13
v_add_u32 v251, s44, v3
v_xor_b32 v252, 64, v251
v_lshrrev_b32 v1, 5, v0
v_and_b32 v2, 31, v0
v_lshlrev_b32 v248, 4, v0
v_and_b32 v4, 15, v0
v_xor_b32 v4, v4, v1
v_lshlrev_b32 v4, 4, v4
v_lshl_add_u32 v4, v2, 8, v4
s_lshl_b32 s44, s40, 13
s_add_u32 s44, s44, 98304
v_add_u32 v249, s44, v4
s_waitcnt lgkmcnt(0)
s_mov_b32 s20, s38
s_mov_b32 s21, s39
s_mov_b32 s22, 33554432
s_mov_b32 s23, 0x20000
s_lshl_b32 s48, s5, 5
s_lshl_b32 s44, s7, 2
s_add_u32 s48, s48, s44
s_lshl_b32 s48, s48, 5
s_lshl_b32 s44, s6, 3
s_add_u32 s48, s48, s44
s_lshl_b32 s48, s48, 11
s_and_b32 s49, s7, 1
s_lshl_b32 s44, s5, 3
s_add_u32 s44, s44, s7
s_lshl_b32 s44, s44, 7
s_add_u32 s88, s44, 4194304
v_mov_b32 v1, 0
buffer_load_dword v238, v1, s[20:23], s88 offen
s_lshl_b32 s45, s41, 17
s_lshl_b32 s44, s42, 0
s_add_u32 s44, s44, s3
s_lshl_b32 s44, s44, 11
s_add_u32 s50, s45, s44
s_add_u32 s50, s50, s48
s_add_u32 s51, s50, 65536
s_xor_b32 s44, s42, s49
s_lshl_b32 s44, s44, 13
s_lshl_b32 s45, s41, 12
s_add_u32 s46, s44, s45
s_add_u32 s46, s46, 81920
s_add_u32 s44, s6, 1
s_and_b32 s44, s44, 3
s_lshl_b32 s60, s44, 6
s_add_u32 s44, s6, 2
s_and_b32 s44, s44, 3
s_lshl_b32 s61, s44, 6
s_add_u32 s44, s6, 3
s_and_b32 s44, s44, 3
s_lshl_b32 s62, s44, 6
s_add_u32 s44, s6, 4
s_and_b32 s44, s44, 3
s_lshl_b32 s63, s44, 6
s_lshl_b32 s44, s5, 3
s_add_u32 s83, s44, s7
s_lshl_b32 s44, s83, 2
s_add_u32 s44, s44, s24
s_lshl_b32 s44, s44, 6
s_add_u32 s72, s44, s40
s_lshl_b32 s45, s6, 2
s_add_u32 s45, s45, s72
s_lshl_b32 s45, s45, 11
s_add_u32 s45, s45, 8388608
s_lshl_b32 s73, s6, 4
s_add_u32 s73, s73, s72
s_lshl_b32 s73, s73, 11
s_add_u32 s73, s73, 8388608
s_lshl_b32 s44, s60, 9
s_add_u32 s76, s44, s45
s_lshl_b32 s44, s60, 7
s_add_u32 s86, s44, s73
s_lshl_b32 s44, s61, 9
s_add_u32 s77, s44, s45
s_lshl_b32 s44, s61, 7
s_add_u32 s87, s44, s73
s_lshl_b32 s44, s62, 9
s_add_u32 s78, s44, s45
s_lshl_b32 s44, s62, 7
s_add_u32 s88, s44, s73
s_lshl_b32 s44, s83, 4
s_add_u32 s44, s44, s40
s_lshl_b32 s44, s44, 2
s_add_u32 s44, s44, s6
s_lshl_b32 s44, s44, 2
s_add_u32 s44, s44, s24
s_lshl_b32 s44, s44, 10
s_add_u32 s79, s44, 20971520
s_add_u32 s83, s79, 65536
s_add_u32 s84, s79, 131072
s_add_u32 s85, s79, 196608
s_mov_b32 s8, s52
s_mov_b32 s9, s53
s_mov_b32 s10, 2359296
s_mov_b32 s11, 0x20000
s_lshl_b32 s44, s7, 2
s_add_u32 s44, s44, s40
s_mul_i32 s44, s44, 73728
s_mul_i32 s45, s5, 1152
s_add_u32 s44, s44, s45
s_lshl_b32 s45, s24, 8
s_add_u32 s44, s44, s45
s_add_u32 s12, s44, s63
s_mov_b32 s73, 0xfffefffe
s_mov_b32 s74, 0x10001
s_mov_b32 s14, 0xffff0000
s_lshl_b32 s80, s40, 13
s_add_u32 s80, s80, 98304
s_lshl_b32 s81, s40, 11
s_add_u32 s81, s81, 81920
s_lshr_b32 s44, s7, 1
s_and_b32 s44, s44, 1
s_mov_b32 s64, 3
s_cmp_eq_u32 s44, 1
s_cselect_b32 s64, 4, s64
s_mov_b32 s65, 5
s_cmp_eq_u32 s44, 1
s_cselect_b32 s65, 6, s65
s_mov_b32 s26, 0x41191411
s_mov_b32 s27, 0x19141191
s_mov_b32 s58, 0
s_mov_b32 s66, 16384
s_mov_b32 s67, 65536
s_mov_b32 s68, 4294885376
s_mov_b32 s59, 0
s_lshr_b32 s44, s2, 3
s_cmp_ge_u32 s44, 2
s_cbranch_scc1 L_nopfc
L_pc:
s_getpc_b64 s[16:17]
s_sub_u32 s16, s16, L_pc+4-concat_heads__mha_block_cached__mha_block_cached__near_ridge_kernel
s_subb_u32 s17, s17, 0
s_mov_b32 s18, L_last-concat_heads__mha_block_cached__mha_block_cached__near_ridge_kernel
s_mov_b32 s19, 0x20000
s_lshl2_add_u32 s44, s44, s40
s_lshl_b32 s44, s44, 13
v_lshlrev_b32 v1, 3, v248
buffer_load_dword v239, v1, s[16:19], s44 offen
s_mov_b32 s59, 1
L_nopfc:
v_mov_b32 v1, 0
s_mov_b64 exec, 1
s_cmp_lg_u32 s40, 1
s_cbranch_scc1 L_nt1
s_lshl_b32 s44, s7, 20
s_add_u32 s16, s30, s44
s_addc_u32 s17, s31, 0
global_load_dword v239, v1, s[16:17]
s_add_u32 s16, s32, s44
s_addc_u32 s17, s33, 0
global_load_dword v239, v1, s[16:17]
s_mul_i32 s44, s6, 1179648
s_add_u32 s16, s36, s44
s_addc_u32 s17, s37, 0
global_load_dword v239, v1, s[16:17]
s_add_u32 s44, s44, 1179644
s_add_u32 s16, s36, s44
s_addc_u32 s17, s37, 0
global_load_dword v239, v1, s[16:17]
s_add_u32 s59, s59, 4
L_nt1:
s_cmp_lg_u32 s40, 2
s_cbranch_scc1 L_nt2
s_add_u32 s16, s38, s50
s_addc_u32 s17, s39, 0
global_load_dword v239, v1, s[16:17]
s_add_u32 s16, s38, s76
s_addc_u32 s17, s39, 0
global_load_dword v239, v1, s[16:17]
s_add_u32 s16, s52, s12
s_addc_u32 s17, s53, 0
global_load_dword v239, v1, s[16:17]
s_add_u32 s16, s38, s79
s_addc_u32 s17, s39, 0
global_load_dword v239, v1, s[16:17]
s_add_u32 s59, s59, 4
L_nt2:
s_mov_b64 exec, -1
v_mov_b32 v0, 0
v_mov_b32 v1, 0
v_mov_b32 v2, 0
v_mov_b32 v3, 0
v_mov_b32 v4, 0
v_mov_b32 v5, 0
v_mov_b32 v6, 0
v_mov_b32 v7, 0
s_cmp_lg_u32 s59, 5
s_cbranch_scc1 L_w5
s_waitcnt vmcnt(6)
s_branch L_wd
L_w5:
s_cmp_lg_u32 s59, 4
s_cbranch_scc1 L_w4
s_waitcnt vmcnt(5)
s_branch L_wd
L_w4:
s_cmp_lg_u32 s59, 1
s_cbranch_scc1 L_w1
s_waitcnt vmcnt(2)
s_branch L_wd
L_w1:
s_waitcnt vmcnt(1)
L_wd:
s_barrier
s_mov_b32 s15, 0
ds_read_b128 v[144:147], v251 offset:0
ds_read_b128 v[148:151], v251 offset:2048
ds_read_b64_tr_b16 v[128:129], v240 offset:0
ds_read_b64_tr_b16 v[130:131], v240 offset:2048
ds_read_b128 v[152:155], v251 offset:4096
ds_read_b128 v[156:159], v251 offset:6144
ds_read_b64_tr_b16 v[132:133], v241 offset:0
ds_read_b64_tr_b16 v[134:135], v241 offset:2048
L_g1:
s_waitcnt lgkmcnt(4)
v_mfma_f32_16x16x32_bf16 v[0:3], v[128:131], v[144:147], v[0:3]
ds_read_b64_tr_b16 v[136:137], v242 offset:0
v_mfma_f32_16x16x32_bf16 v[32:35], v[128:131], v[148:151], v[32:35]
v_add_u32 v246, s15, v246
s_waitcnt lgkmcnt(3)
v_mfma_f32_16x16x32_bf16 v[64:67], v[128:131], v[152:155], v[64:67]
ds_read_b64_tr_b16 v[138:139], v242 offset:2048
v_mfma_f32_16x16x32_bf16 v[96:99], v[128:131], v[156:159], v[96:99]
v_add_u32 v247, s15, v247
s_waitcnt lgkmcnt(2)
v_mfma_f32_16x16x32_bf16 v[4:7], v[132:135], v[144:147], v[4:7]
ds_read_b64_tr_b16 v[140:141], v243 offset:0
v_mfma_f32_16x16x32_bf16 v[36:39], v[132:135], v[148:151], v[36:39]
ds_read_b64_tr_b16 v[142:143], v243 offset:2048
v_mfma_f32_16x16x32_bf16 v[68:71], v[132:135], v[152:155], v[68:71]
s_bfe_i32 s15, s26, 0x40000
s_lshr_b64 s[26:27], s[26:27], 4
v_mfma_f32_16x16x32_bf16 v[100:103], v[132:135], v[156:159], v[100:103]
s_cmp_eq_u32 s58, s64
s_cbranch_scc0 L_nk
s_call_b64 s[70:71], L_kread
L_nk:
s_waitcnt lgkmcnt(2)
v_mfma_f32_16x16x32_bf16 v[8:11], v[136:139], v[144:147], v[8:11]
ds_read_b64_tr_b16 v[128:129], v244 offset:0
v_mfma_f32_16x16x32_bf16 v[40:43], v[136:139], v[148:151], v[40:43]
ds_read_b64_tr_b16 v[130:131], v244 offset:2048
v_mfma_f32_16x16x32_bf16 v[72:75], v[136:139], v[152:155], v[72:75]
s_lshl_b32 s15, s15, 14
v_mfma_f32_16x16x32_bf16 v[104:107], v[136:139], v[156:159], v[104:107]
s_waitcnt lgkmcnt(2)
v_mfma_f32_16x16x32_bf16 v[12:15], v[140:143], v[144:147], v[12:15]
ds_read_b64_tr_b16 v[132:133], v245 offset:0
v_mfma_f32_16x16x32_bf16 v[44:47], v[140:143], v[148:151], v[44:47]
ds_read_b64_tr_b16 v[134:135], v245 offset:2048
v_mfma_f32_16x16x32_bf16 v[76:79], v[140:143], v[152:155], v[76:79]
v_mfma_f32_16x16x32_bf16 v[108:111], v[140:143], v[156:159], v[108:111]
s_waitcnt lgkmcnt(2)
v_mfma_f32_16x16x32_bf16 v[16:19], v[128:131], v[144:147], v[16:19]
ds_read_b64_tr_b16 v[136:137], v246 offset:0
v_mfma_f32_16x16x32_bf16 v[48:51], v[128:131], v[148:151], v[48:51]
ds_read_b64_tr_b16 v[138:139], v246 offset:2048
v_mfma_f32_16x16x32_bf16 v[80:83], v[128:131], v[152:155], v[80:83]
ds_read_b64_tr_b16 v[140:141], v247 offset:0
v_mfma_f32_16x16x32_bf16 v[112:115], v[128:131], v[156:159], v[112:115]
ds_read_b64_tr_b16 v[142:143], v247 offset:2048
s_waitcnt lgkmcnt(4)
v_mfma_f32_16x16x32_bf16 v[20:23], v[132:135], v[144:147], v[20:23]
v_add_u32 v240, s15, v240
v_add_u32 v241, s15, v241
v_mfma_f32_16x16x32_bf16 v[52:55], v[132:135], v[148:151], v[52:55]
v_add_u32 v242, s15, v242
v_add_u32 v243, s15, v243
v_mfma_f32_16x16x32_bf16 v[84:87], v[132:135], v[152:155], v[84:87]
v_add_u32 v244, s15, v244
v_add_u32 v245, s15, v245
v_mfma_f32_16x16x32_bf16 v[116:119], v[132:135], v[156:159], v[116:119]
s_waitcnt lgkmcnt(0)
s_barrier
v_mfma_f32_16x16x32_bf16 v[24:27], v[136:139], v[144:147], v[24:27]
ds_read_b128 v[160:163], v252 offset:0
v_mfma_f32_16x16x32_bf16 v[56:59], v[136:139], v[148:151], v[56:59]
ds_read_b128 v[164:167], v252 offset:2048
v_mfma_f32_16x16x32_bf16 v[88:91], v[136:139], v[152:155], v[88:91]
ds_read_b64_tr_b16 v[128:129], v240 offset:0
v_mfma_f32_16x16x32_bf16 v[120:123], v[136:139], v[156:159], v[120:123]
ds_read_b64_tr_b16 v[130:131], v240 offset:2048
v_mfma_f32_16x16x32_bf16 v[28:31], v[140:143], v[144:147], v[28:31]
ds_read_b128 v[168:171], v252 offset:4096
v_mfma_f32_16x16x32_bf16 v[60:63], v[140:143], v[148:151], v[60:63]
ds_read_b128 v[172:175], v252 offset:6144
v_mfma_f32_16x16x32_bf16 v[92:95], v[140:143], v[152:155], v[92:95]
ds_read_b64_tr_b16 v[132:133], v241 offset:0
v_mfma_f32_16x16x32_bf16 v[124:127], v[140:143], v[156:159], v[124:127]
ds_read_b64_tr_b16 v[134:135], v241 offset:2048
s_waitcnt lgkmcnt(4)
v_mfma_f32_16x16x32_bf16 v[0:3], v[128:131], v[160:163], v[0:3]
ds_read_b64_tr_b16 v[136:137], v242 offset:0
v_mfma_f32_16x16x32_bf16 v[32:35], v[128:131], v[164:167], v[32:35]
v_add_u32 v246, s15, v246
s_waitcnt lgkmcnt(3)
v_mfma_f32_16x16x32_bf16 v[64:67], v[128:131], v[168:171], v[64:67]
ds_read_b64_tr_b16 v[138:139], v242 offset:2048
v_mfma_f32_16x16x32_bf16 v[96:99], v[128:131], v[172:175], v[96:99]
v_add_u32 v247, s15, v247
s_waitcnt lgkmcnt(2)
v_mfma_f32_16x16x32_bf16 v[4:7], v[132:135], v[160:163], v[4:7]
ds_read_b64_tr_b16 v[140:141], v243 offset:0
v_mfma_f32_16x16x32_bf16 v[36:39], v[132:135], v[164:167], v[36:39]
ds_read_b64_tr_b16 v[142:143], v243 offset:2048
v_mfma_f32_16x16x32_bf16 v[68:71], v[132:135], v[168:171], v[68:71]
s_bfe_i32 s15, s26, 0x40000
s_lshr_b64 s[26:27], s[26:27], 4
v_mfma_f32_16x16x32_bf16 v[100:103], v[132:135], v[172:175], v[100:103]
s_add_u32 s58, s58, 1
s_waitcnt lgkmcnt(2)
v_mfma_f32_16x16x32_bf16 v[8:11], v[136:139], v[160:163], v[8:11]
ds_read_b64_tr_b16 v[128:129], v244 offset:0
v_mfma_f32_16x16x32_bf16 v[40:43], v[136:139], v[164:167], v[40:43]
ds_read_b64_tr_b16 v[130:131], v244 offset:2048
v_mfma_f32_16x16x32_bf16 v[72:75], v[136:139], v[168:171], v[72:75]
s_lshl_b32 s15, s15, 14
v_add_u32 v251, s66, v251
v_mfma_f32_16x16x32_bf16 v[104:107], v[136:139], v[172:175], v[104:107]
s_waitcnt lgkmcnt(2)
v_mfma_f32_16x16x32_bf16 v[12:15], v[140:143], v[160:163], v[12:15]
ds_read_b64_tr_b16 v[132:133], v245 offset:0
v_mfma_f32_16x16x32_bf16 v[44:47], v[140:143], v[164:167], v[44:47]
ds_read_b64_tr_b16 v[134:135], v245 offset:2048
v_mfma_f32_16x16x32_bf16 v[76:79], v[140:143], v[168:171], v[76:79]
v_add_u32 v252, s66, v252
s_mov_b32 s44, s66
v_mfma_f32_16x16x32_bf16 v[108:111], v[140:143], v[172:175], v[108:111]
s_mov_b32 s66, s67
s_waitcnt lgkmcnt(2)
v_mfma_f32_16x16x32_bf16 v[16:19], v[128:131], v[160:163], v[16:19]
ds_read_b64_tr_b16 v[136:137], v246 offset:0
v_mfma_f32_16x16x32_bf16 v[48:51], v[128:131], v[164:167], v[48:51]
ds_read_b64_tr_b16 v[138:139], v246 offset:2048
s_mov_b32 s67, s68
v_mfma_f32_16x16x32_bf16 v[80:83], v[128:131], v[168:171], v[80:83]
ds_read_b64_tr_b16 v[140:141], v247 offset:0
v_mfma_f32_16x16x32_bf16 v[112:115], v[128:131], v[172:175], v[112:115]
ds_read_b64_tr_b16 v[142:143], v247 offset:2048
s_mov_b32 s68, s44
s_waitcnt lgkmcnt(4)
v_mfma_f32_16x16x32_bf16 v[20:23], v[132:135], v[160:163], v[20:23]
v_add_u32 v240, s15, v240
v_add_u32 v241, s15, v241
v_mfma_f32_16x16x32_bf16 v[52:55], v[132:135], v[164:167], v[52:55]
v_add_u32 v242, s15, v242
v_add_u32 v243, s15, v243
v_mfma_f32_16x16x32_bf16 v[84:87], v[132:135], v[168:171], v[84:87]
v_add_u32 v244, s15, v244
v_add_u32 v245, s15, v245
v_mfma_f32_16x16x32_bf16 v[116:119], v[132:135], v[172:175], v[116:119]
s_waitcnt lgkmcnt(0)
s_barrier
v_mfma_f32_16x16x32_bf16 v[24:27], v[136:139], v[160:163], v[24:27]
ds_read_b128 v[144:147], v251 offset:0
v_mfma_f32_16x16x32_bf16 v[56:59], v[136:139], v[164:167], v[56:59]
ds_read_b128 v[148:151], v251 offset:2048
v_mfma_f32_16x16x32_bf16 v[88:91], v[136:139], v[168:171], v[88:91]
ds_read_b64_tr_b16 v[128:129], v240 offset:0
v_mfma_f32_16x16x32_bf16 v[120:123], v[136:139], v[172:175], v[120:123]
ds_read_b64_tr_b16 v[130:131], v240 offset:2048
v_mfma_f32_16x16x32_bf16 v[28:31], v[140:143], v[160:163], v[28:31]
ds_read_b128 v[152:155], v251 offset:4096
v_mfma_f32_16x16x32_bf16 v[60:63], v[140:143], v[164:167], v[60:63]
ds_read_b128 v[156:159], v251 offset:6144
v_mfma_f32_16x16x32_bf16 v[92:95], v[140:143], v[168:171], v[92:95]
ds_read_b64_tr_b16 v[132:133], v241 offset:0
s_cmp_lt_u32 s58, 8
v_mfma_f32_16x16x32_bf16 v[124:127], v[140:143], v[172:175], v[124:127]
ds_read_b64_tr_b16 v[134:135], v241 offset:2048
s_cbranch_scc1 L_g1
s_waitcnt lgkmcnt(4)
v_mfma_f32_16x16x32_bf16 v[0:3], v[128:131], v[144:147], v[0:3]
ds_read_b64_tr_b16 v[136:137], v242 offset:0
v_mfma_f32_16x16x32_bf16 v[32:35], v[128:131], v[148:151], v[32:35]
v_add_u32 v246, s15, v246
s_waitcnt lgkmcnt(3)
v_mfma_f32_16x16x32_bf16 v[64:67], v[128:131], v[152:155], v[64:67]
ds_read_b64_tr_b16 v[138:139], v242 offset:2048
v_mfma_f32_16x16x32_bf16 v[96:99], v[128:131], v[156:159], v[96:99]
v_add_u32 v247, s15, v247
s_waitcnt lgkmcnt(2)
v_mfma_f32_16x16x32_bf16 v[4:7], v[132:135], v[144:147], v[4:7]
ds_read_b64_tr_b16 v[140:141], v243 offset:0
v_mfma_f32_16x16x32_bf16 v[36:39], v[132:135], v[148:151], v[36:39]
ds_read_b64_tr_b16 v[142:143], v243 offset:2048
v_mfma_f32_16x16x32_bf16 v[68:71], v[132:135], v[152:155], v[68:71]
s_mov_b32 s15, 16384
v_mfma_f32_16x16x32_bf16 v[100:103], v[132:135], v[156:159], v[100:103]
s_waitcnt lgkmcnt(2)
v_mfma_f32_16x16x32_bf16 v[8:11], v[136:139], v[144:147], v[8:11]
ds_read_b64_tr_b16 v[128:129], v244 offset:0
v_mfma_f32_16x16x32_bf16 v[40:43], v[136:139], v[148:151], v[40:43]
ds_read_b64_tr_b16 v[130:131], v244 offset:2048
v_mfma_f32_16x16x32_bf16 v[72:75], v[136:139], v[152:155], v[72:75]
v_mfma_f32_16x16x32_bf16 v[104:107], v[136:139], v[156:159], v[104:107]
s_waitcnt lgkmcnt(2)
v_mfma_f32_16x16x32_bf16 v[12:15], v[140:143], v[144:147], v[12:15]
ds_read_b64_tr_b16 v[132:133], v245 offset:0
v_mfma_f32_16x16x32_bf16 v[44:47], v[140:143], v[148:151], v[44:47]
ds_read_b64_tr_b16 v[134:135], v245 offset:2048
v_mfma_f32_16x16x32_bf16 v[76:79], v[140:143], v[152:155], v[76:79]
v_mfma_f32_16x16x32_bf16 v[108:111], v[140:143], v[156:159], v[108:111]
s_waitcnt lgkmcnt(2)
v_mfma_f32_16x16x32_bf16 v[16:19], v[128:131], v[144:147], v[16:19]
ds_read_b64_tr_b16 v[136:137], v246 offset:0
v_mfma_f32_16x16x32_bf16 v[48:51], v[128:131], v[148:151], v[48:51]
ds_read_b64_tr_b16 v[138:139], v246 offset:2048
v_mfma_f32_16x16x32_bf16 v[80:83], v[128:131], v[152:155], v[80:83]
ds_read_b64_tr_b16 v[140:141], v247 offset:0
v_mfma_f32_16x16x32_bf16 v[112:115], v[128:131], v[156:159], v[112:115]
ds_read_b64_tr_b16 v[142:143], v247 offset:2048
s_waitcnt lgkmcnt(4)
v_mfma_f32_16x16x32_bf16 v[20:23], v[132:135], v[144:147], v[20:23]
v_add_u32 v240, s15, v240
v_add_u32 v241, s15, v241
v_mfma_f32_16x16x32_bf16 v[52:55], v[132:135], v[148:151], v[52:55]
v_add_u32 v242, s15, v242
v_add_u32 v243, s15, v243
v_mfma_f32_16x16x32_bf16 v[84:87], v[132:135], v[152:155], v[84:87]
v_add_u32 v244, s15, v244
v_add_u32 v245, s15, v245
v_mfma_f32_16x16x32_bf16 v[116:119], v[132:135], v[156:159], v[116:119]
s_waitcnt lgkmcnt(0)
s_barrier
v_mfma_f32_16x16x32_bf16 v[24:27], v[136:139], v[144:147], v[24:27]
ds_read_b128 v[160:163], v252 offset:0
v_mfma_f32_16x16x32_bf16 v[56:59], v[136:139], v[148:151], v[56:59]
ds_read_b128 v[164:167], v252 offset:2048
v_mfma_f32_16x16x32_bf16 v[88:91], v[136:139], v[152:155], v[88:91]
ds_read_b64_tr_b16 v[128:129], v240 offset:0
v_mfma_f32_16x16x32_bf16 v[120:123], v[136:139], v[156:159], v[120:123]
ds_read_b64_tr_b16 v[130:131], v240 offset:2048
v_mfma_f32_16x16x32_bf16 v[28:31], v[140:143], v[144:147], v[28:31]
ds_read_b128 v[168:171], v252 offset:4096
v_mfma_f32_16x16x32_bf16 v[60:63], v[140:143], v[148:151], v[60:63]
ds_read_b128 v[172:175], v252 offset:6144
v_mfma_f32_16x16x32_bf16 v[92:95], v[140:143], v[152:155], v[92:95]
ds_read_b64_tr_b16 v[132:133], v241 offset:0
v_mfma_f32_16x16x32_bf16 v[124:127], v[140:143], v[156:159], v[124:127]
ds_read_b64_tr_b16 v[134:135], v241 offset:2048
s_waitcnt lgkmcnt(4)
v_mfma_f32_16x16x32_bf16 v[0:3], v[128:131], v[160:163], v[0:3]
ds_read_b64_tr_b16 v[136:137], v242 offset:0
v_mfma_f32_16x16x32_bf16 v[32:35], v[128:131], v[164:167], v[32:35]
v_add_u32 v246, s15, v246
s_waitcnt lgkmcnt(3)
v_mfma_f32_16x16x32_bf16 v[64:67], v[128:131], v[168:171], v[64:67]
ds_read_b64_tr_b16 v[138:139], v242 offset:2048
v_mfma_f32_16x16x32_bf16 v[96:99], v[128:131], v[172:175], v[96:99]
v_add_u32 v247, s15, v247
s_waitcnt lgkmcnt(2)
v_mfma_f32_16x16x32_bf16 v[4:7], v[132:135], v[160:163], v[4:7]
ds_read_b64_tr_b16 v[140:141], v243 offset:0
v_mfma_f32_16x16x32_bf16 v[36:39], v[132:135], v[164:167], v[36:39]
ds_read_b64_tr_b16 v[142:143], v243 offset:2048
v_mfma_f32_16x16x32_bf16 v[68:71], v[132:135], v[168:171], v[68:71]
v_mfma_f32_16x16x32_bf16 v[100:103], v[132:135], v[172:175], v[100:103]
s_waitcnt lgkmcnt(2)
v_mfma_f32_16x16x32_bf16 v[8:11], v[136:139], v[160:163], v[8:11]
ds_read_b64_tr_b16 v[128:129], v244 offset:0
v_mfma_f32_16x16x32_bf16 v[40:43], v[136:139], v[164:167], v[40:43]
ds_read_b64_tr_b16 v[130:131], v244 offset:2048
v_mfma_f32_16x16x32_bf16 v[72:75], v[136:139], v[168:171], v[72:75]
v_mfma_f32_16x16x32_bf16 v[104:107], v[136:139], v[172:175], v[104:107]
s_waitcnt lgkmcnt(2)
v_mfma_f32_16x16x32_bf16 v[12:15], v[140:143], v[160:163], v[12:15]
ds_read_b64_tr_b16 v[132:133], v245 offset:0
v_mfma_f32_16x16x32_bf16 v[44:47], v[140:143], v[164:167], v[44:47]
ds_read_b64_tr_b16 v[134:135], v245 offset:2048
v_mfma_f32_16x16x32_bf16 v[76:79], v[140:143], v[168:171], v[76:79]
v_cvt_pk_bf16_f32 v0, v0, v1
v_cvt_pk_bf16_f32 v1, v2, v3
v_mfma_f32_16x16x32_bf16 v[108:111], v[140:143], v[172:175], v[108:111]
v_cvt_pk_bf16_f32 v2, v4, v5
s_waitcnt lgkmcnt(2)
v_mfma_f32_16x16x32_bf16 v[16:19], v[128:131], v[160:163], v[16:19]
ds_read_b64_tr_b16 v[136:137], v246 offset:0
v_mfma_f32_16x16x32_bf16 v[48:51], v[128:131], v[164:167], v[48:51]
ds_read_b64_tr_b16 v[138:139], v246 offset:2048
v_mfma_f32_16x16x32_bf16 v[80:83], v[128:131], v[168:171], v[80:83]
ds_read_b64_tr_b16 v[140:141], v247 offset:0
v_mfma_f32_16x16x32_bf16 v[112:115], v[128:131], v[172:175], v[112:115]
ds_read_b64_tr_b16 v[142:143], v247 offset:2048
s_waitcnt lgkmcnt(4)
v_mfma_f32_16x16x32_bf16 v[20:23], v[132:135], v[160:163], v[20:23]
v_cvt_pk_bf16_f32 v3, v6, v7
v_cvt_pk_bf16_f32 v32, v32, v33
v_mfma_f32_16x16x32_bf16 v[52:55], v[132:135], v[164:167], v[52:55]
v_cvt_pk_bf16_f32 v33, v34, v35
v_cvt_pk_bf16_f32 v34, v36, v37
v_mfma_f32_16x16x32_bf16 v[84:87], v[132:135], v[168:171], v[84:87]
v_cvt_pk_bf16_f32 v35, v38, v39
v_cvt_pk_bf16_f32 v64, v64, v65
v_mfma_f32_16x16x32_bf16 v[116:119], v[132:135], v[172:175], v[116:119]
s_waitcnt lgkmcnt(0)
s_barrier
v_mfma_f32_16x16x32_bf16 v[24:27], v[136:139], v[160:163], v[24:27]
v_permlane16_swap_b32 v0, v32
v_permlane16_swap_b32 v1, v33
v_mfma_f32_16x16x32_bf16 v[56:59], v[136:139], v[164:167], v[56:59]
v_permlane16_swap_b32 v2, v34
v_permlane16_swap_b32 v3, v35
v_mfma_f32_16x16x32_bf16 v[88:91], v[136:139], v[168:171], v[88:91]
v_cvt_pk_bf16_f32 v65, v66, v67
v_cvt_pk_bf16_f32 v66, v68, v69
v_mfma_f32_16x16x32_bf16 v[120:123], v[136:139], v[172:175], v[120:123]
v_cvt_pk_bf16_f32 v67, v70, v71
v_mfma_f32_16x16x32_bf16 v[28:31], v[140:143], v[160:163], v[28:31]
v_cvt_pk_bf16_f32 v96, v96, v97
v_cvt_pk_bf16_f32 v97, v98, v99
v_mfma_f32_16x16x32_bf16 v[60:63], v[140:143], v[164:167], v[60:63]
v_cvt_pk_bf16_f32 v98, v100, v101
v_cvt_pk_bf16_f32 v99, v102, v103
v_mfma_f32_16x16x32_bf16 v[92:95], v[140:143], v[168:171], v[92:95]
v_permlane16_swap_b32 v64, v96
v_permlane16_swap_b32 v65, v97
v_mfma_f32_16x16x32_bf16 v[124:127], v[140:143], v[172:175], v[124:127]
v_permlane16_swap_b32 v66, v98
v_permlane16_swap_b32 v67, v99
v_mfma_f32_32x32x16_bf16 v[128:143], v[176:179], v[0:3], 0
v_cvt_pk_bf16_f32 v8, v8, v9
v_cvt_pk_bf16_f32 v9, v10, v11
v_cvt_pk_bf16_f32 v10, v12, v13
v_cvt_pk_bf16_f32 v11, v14, v15
v_cvt_pk_bf16_f32 v40, v40, v41
v_cvt_pk_bf16_f32 v41, v42, v43
v_mfma_f32_32x32x16_bf16 v[144:159], v[208:211], v[64:67], 0
v_cvt_pk_bf16_f32 v42, v44, v45
v_cvt_pk_bf16_f32 v43, v46, v47
v_cvt_pk_bf16_f32 v72, v72, v73
v_cvt_pk_bf16_f32 v73, v74, v75
v_cvt_pk_bf16_f32 v74, v76, v77
v_cvt_pk_bf16_f32 v75, v78, v79
v_mfma_f32_32x32x16_bf16 v[128:143], v[180:183], v[32:35], v[128:143]
v_permlane16_swap_b32 v8, v40
v_permlane16_swap_b32 v9, v41
v_permlane16_swap_b32 v10, v42
v_permlane16_swap_b32 v11, v43
v_cvt_pk_bf16_f32 v104, v104, v105
v_cvt_pk_bf16_f32 v105, v106, v107
v_cvt_pk_bf16_f32 v106, v108, v109
v_cvt_pk_bf16_f32 v107, v110, v111
v_mfma_f32_32x32x16_bf16 v[144:159], v[212:215], v[96:99], v[144:159]
v_permlane16_swap_b32 v72, v104
v_permlane16_swap_b32 v73, v105
v_permlane16_swap_b32 v74, v106
v_permlane16_swap_b32 v75, v107
v_cvt_pk_bf16_f32 v16, v16, v17
v_cvt_pk_bf16_f32 v17, v18, v19
v_mfma_f32_32x32x16_bf16 v[128:143], v[184:187], v[8:11], v[128:143]
v_cvt_pk_bf16_f32 v18, v20, v21
v_cvt_pk_bf16_f32 v19, v22, v23
v_cvt_pk_bf16_f32 v48, v48, v49
v_cvt_pk_bf16_f32 v49, v50, v51
v_cvt_pk_bf16_f32 v50, v52, v53
v_cvt_pk_bf16_f32 v51, v54, v55
v_mfma_f32_32x32x16_bf16 v[144:159], v[216:219], v[72:75], v[144:159]
v_permlane16_swap_b32 v16, v48
v_permlane16_swap_b32 v17, v49
v_permlane16_swap_b32 v18, v50
v_permlane16_swap_b32 v19, v51
v_cvt_pk_bf16_f32 v80, v80, v81
v_cvt_pk_bf16_f32 v81, v82, v83
v_mfma_f32_32x32x16_bf16 v[128:143], v[188:191], v[40:43], v[128:143]
v_cvt_pk_bf16_f32 v82, v84, v85
v_cvt_pk_bf16_f32 v83, v86, v87
v_cvt_pk_bf16_f32 v112, v112, v113
v_cvt_pk_bf16_f32 v113, v114, v115
v_cvt_pk_bf16_f32 v114, v116, v117
v_cvt_pk_bf16_f32 v115, v118, v119
v_mfma_f32_32x32x16_bf16 v[144:159], v[220:223], v[104:107], v[144:159]
v_permlane16_swap_b32 v80, v112
v_permlane16_swap_b32 v81, v113
v_permlane16_swap_b32 v82, v114
v_permlane16_swap_b32 v83, v115
v_cvt_pk_bf16_f32 v24, v24, v25
v_cvt_pk_bf16_f32 v25, v26, v27
v_mfma_f32_32x32x16_bf16 v[128:143], v[192:195], v[16:19], v[128:143]
v_cvt_pk_bf16_f32 v26, v28, v29
v_cvt_pk_bf16_f32 v27, v30, v31
v_cvt_pk_bf16_f32 v56, v56, v57
v_cvt_pk_bf16_f32 v57, v58, v59
v_cvt_pk_bf16_f32 v58, v60, v61
v_cvt_pk_bf16_f32 v59, v62, v63
v_mfma_f32_32x32x16_bf16 v[144:159], v[224:227], v[80:83], v[144:159]
v_permlane16_swap_b32 v24, v56
v_permlane16_swap_b32 v25, v57
v_permlane16_swap_b32 v26, v58
v_permlane16_swap_b32 v27, v59
v_cvt_pk_bf16_f32 v88, v88, v89
v_cvt_pk_bf16_f32 v89, v90, v91
v_mfma_f32_32x32x16_bf16 v[128:143], v[196:199], v[48:51], v[128:143]
v_cvt_pk_bf16_f32 v90, v92, v93
v_cvt_pk_bf16_f32 v91, v94, v95
v_cvt_pk_bf16_f32 v120, v120, v121
v_cvt_pk_bf16_f32 v121, v122, v123
v_cvt_pk_bf16_f32 v122, v124, v125
v_cvt_pk_bf16_f32 v123, v126, v127
v_mfma_f32_32x32x16_bf16 v[144:159], v[228:231], v[112:115], v[144:159]
v_permlane16_swap_b32 v88, v120
v_permlane16_swap_b32 v89, v121
v_permlane16_swap_b32 v90, v122
v_permlane16_swap_b32 v91, v123
v_lshrrev_b32 v251, 9, v248
v_bfe_u32 v252, v248, 6, 2
v_mfma_f32_32x32x16_bf16 v[128:143], v[200:203], v[24:27], v[128:143]
v_bfe_u32 v244, v248, 4, 2
v_bfe_u32 v246, v248, 8, 1
v_lshl_add_u32 v251, v251, 2, v252
v_lshlrev_b32 v246, 5, v246
v_lshl_add_u32 v246, v244, 3, v246
v_lshl_add_u32 v250, v251, 8, v246
v_mfma_f32_32x32x16_bf16 v[144:159], v[232:235], v[88:91], v[144:159]
v_lshl_add_u32 v240, v252, 6, v250
v_add_u32 v241, s80, v240
v_lshl_add_u32 v250, v251, 7, v246
v_lshrrev_b32 v252, 1, v252
v_lshl_add_u32 v250, v252, 6, v250
v_add_u32 v242, 65536, v250
v_mfma_f32_32x32x16_bf16 v[128:143], v[204:207], v[56:59], v[128:143]
v_xor_b32 v243, 64, v242
v_add_u32 v245, s81, v248
v_mul_u32_u24 v250, 0x55, v244
v_add_u32 v250, s56, v250
v_bfe_u32 v244, v250, 0, 2
v_mul_u32_u24 v244, 0x8001, v244
v_mfma_f32_32x32x16_bf16 v[144:159], v[236:239], v[120:123], v[144:159]
v_and_b32 v244, s74, v244
v_bfe_u32 v246, v250, 2, 2
v_mul_u32_u24 v246, 0x8001, v246
v_and_b32 v246, s74, v246
v_bfe_u32 v247, v250, 4, 2
v_mul_u32_u24 v247, 0x8001, v247
v_and_b32 v247, s74, v247
v_bfe_u32 v249, v250, 6, 2
v_mul_u32_u24 v249, 0x8001, v249
v_and_b32 v249, s74, v249
v_xor_b32 v64, 0, v241
v_xor_b32 v65, 64, v241
v_xor_b32 v66, 128, v241
v_xor_b32 v67, 192, v241
v_xor_b32 v68, s60, v240
v_xor_b32 v69, s61, v240
v_xor_b32 v70, s62, v240
v_xor_b32 v71, s63, v240
s_mov_b32 s44, 0x3e0293ee
s_mov_b32 s45, 0x3e0293ee
v_add_u32 v6, s46, v248
s_mov_b32 s57, 0x7fff7fff
v_max3_f32 v0, v128, v129, v130
v_max3_f32 v4, v144, v145, v146
v_max3_f32 v0, v0, v131, v132
v_max3_f32 v4, v4, v147, v148
v_max3_f32 v0, v0, v133, v134
v_max3_f32 v4, v4, v149, v150
v_max3_f32 v0, v0, v135, v136
v_max3_f32 v4, v4, v151, v152
v_max3_f32 v0, v0, v137, v138
v_max3_f32 v4, v4, v153, v154
v_max3_f32 v0, v0, v139, v140
v_max3_f32 v4, v4, v155, v156
v_max3_f32 v0, v0, v141, v142
v_max3_f32 v4, v4, v157, v158
v_max_f32 v0, v0, v143
v_max_f32 v4, v4, v159
v_mov_b32 v1, v0
v_mov_b32 v5, v4
s_nop 0
v_permlane32_swap_b32 v0, v1
v_permlane32_swap_b32 v4, v5
s_nop 0
v_max_f32 v0, v0, v1
v_max_f32 v4, v4, v5
v_mul_f32 v0, s44, v0
v_mul_f32 v4, s44, v4
v_pk_fma_f32 v[128:129], v[128:129], s[44:45], v[0:1] op_sel_hi:[1,0,0] neg_lo:[0,0,1] neg_hi:[0,0,1]
v_pk_fma_f32 v[130:131], v[130:131], s[44:45], v[0:1] op_sel_hi:[1,0,0] neg_lo:[0,0,1] neg_hi:[0,0,1]
v_pk_fma_f32 v[132:133], v[132:133], s[44:45], v[0:1] op_sel_hi:[1,0,0] neg_lo:[0,0,1] neg_hi:[0,0,1]
v_pk_fma_f32 v[134:135], v[134:135], s[44:45], v[0:1] op_sel_hi:[1,0,0] neg_lo:[0,0,1] neg_hi:[0,0,1]
v_pk_fma_f32 v[136:137], v[136:137], s[44:45], v[0:1] op_sel_hi:[1,0,0] neg_lo:[0,0,1] neg_hi:[0,0,1]
v_pk_fma_f32 v[138:139], v[138:139], s[44:45], v[0:1] op_sel_hi:[1,0,0] neg_lo:[0,0,1] neg_hi:[0,0,1]
v_pk_fma_f32 v[140:141], v[140:141], s[44:45], v[0:1] op_sel_hi:[1,0,0] neg_lo:[0,0,1] neg_hi:[0,0,1]
v_pk_fma_f32 v[142:143], v[142:143], s[44:45], v[0:1] op_sel_hi:[1,0,0] neg_lo:[0,0,1] neg_hi:[0,0,1]
v_exp_f32 v128, v128
v_exp_f32 v129, v129
v_exp_f32 v130, v130
v_exp_f32 v131, v131
v_exp_f32 v132, v132
v_exp_f32 v133, v133
v_exp_f32 v134, v134
v_exp_f32 v135, v135
v_exp_f32 v136, v136
v_exp_f32 v137, v137
v_exp_f32 v138, v138
v_exp_f32 v139, v139
v_exp_f32 v140, v140
v_exp_f32 v141, v141
v_exp_f32 v142, v142
v_exp_f32 v143, v143
v_pk_fma_f32 v[144:145], v[144:145], s[44:45], v[4:5] op_sel_hi:[1,0,0] neg_lo:[0,0,1] neg_hi:[0,0,1]
v_pk_fma_f32 v[146:147], v[146:147], s[44:45], v[4:5] op_sel_hi:[1,0,0] neg_lo:[0,0,1] neg_hi:[0,0,1]
v_pk_fma_f32 v[148:149], v[148:149], s[44:45], v[4:5] op_sel_hi:[1,0,0] neg_lo:[0,0,1] neg_hi:[0,0,1]
v_pk_fma_f32 v[150:151], v[150:151], s[44:45], v[4:5] op_sel_hi:[1,0,0] neg_lo:[0,0,1] neg_hi:[0,0,1]
v_pk_fma_f32 v[152:153], v[152:153], s[44:45], v[4:5] op_sel_hi:[1,0,0] neg_lo:[0,0,1] neg_hi:[0,0,1]
v_pk_fma_f32 v[154:155], v[154:155], s[44:45], v[4:5] op_sel_hi:[1,0,0] neg_lo:[0,0,1] neg_hi:[0,0,1]
v_pk_fma_f32 v[156:157], v[156:157], s[44:45], v[4:5] op_sel_hi:[1,0,0] neg_lo:[0,0,1] neg_hi:[0,0,1]
v_pk_fma_f32 v[158:159], v[158:159], s[44:45], v[4:5] op_sel_hi:[1,0,0] neg_lo:[0,0,1] neg_hi:[0,0,1]
v_exp_f32 v144, v144
v_exp_f32 v145, v145
v_exp_f32 v146, v146
v_exp_f32 v147, v147
v_exp_f32 v148, v148
v_exp_f32 v149, v149
v_exp_f32 v150, v150
v_exp_f32 v151, v151
v_exp_f32 v152, v152
v_exp_f32 v153, v153
v_exp_f32 v154, v154
v_exp_f32 v155, v155
v_exp_f32 v156, v156
v_exp_f32 v157, v157
v_exp_f32 v158, v158
v_exp_f32 v159, v159
v_pk_add_f32 v[0:1], v[128:129], v[130:131]
v_pk_add_f32 v[4:5], v[144:145], v[146:147]
v_pk_add_f32 v[0:1], v[0:1], v[132:133]
v_pk_add_f32 v[4:5], v[4:5], v[148:149]
v_pk_add_f32 v[0:1], v[0:1], v[134:135]
v_pk_add_f32 v[4:5], v[4:5], v[150:151]
v_pk_add_f32 v[0:1], v[0:1], v[136:137]
v_pk_add_f32 v[4:5], v[4:5], v[152:153]
v_pk_add_f32 v[0:1], v[0:1], v[138:139]
v_pk_add_f32 v[4:5], v[4:5], v[154:155]
v_pk_add_f32 v[0:1], v[0:1], v[140:141]
v_pk_add_f32 v[4:5], v[4:5], v[156:157]
v_pk_add_f32 v[0:1], v[0:1], v[142:143]
v_pk_add_f32 v[4:5], v[4:5], v[158:159]
v_add_f32 v0, v0, v1
v_add_f32 v4, v4, v5
v_mov_b32 v1, v0
v_mov_b32 v5, v4
s_nop 0
v_permlane32_swap_b32 v0, v1
v_permlane32_swap_b32 v4, v5
s_nop 0
v_add_f32 v0, v0, v1
v_add_f32 v4, v4, v5
v_rcp_f32 v0, v0
v_rcp_f32 v4, v4
s_nop 0
v_pk_mul_f32 v[128:129], v[128:129], v[0:1] op_sel_hi:[1,0]
v_pk_mul_f32 v[130:131], v[130:131], v[0:1] op_sel_hi:[1,0]
v_pk_mul_f32 v[132:133], v[132:133], v[0:1] op_sel_hi:[1,0]
v_pk_mul_f32 v[134:135], v[134:135], v[0:1] op_sel_hi:[1,0]
v_pk_mul_f32 v[136:137], v[136:137], v[0:1] op_sel_hi:[1,0]
v_pk_mul_f32 v[138:139], v[138:139], v[0:1] op_sel_hi:[1,0]
v_pk_mul_f32 v[140:141], v[140:141], v[0:1] op_sel_hi:[1,0]
v_pk_mul_f32 v[142:143], v[142:143], v[0:1] op_sel_hi:[1,0]
v_cvt_pk_bf16_f32 v128, v128, v129
v_cvt_pk_bf16_f32 v129, v130, v131
v_cvt_pk_bf16_f32 v130, v132, v133
v_cvt_pk_bf16_f32 v131, v134, v135
v_cvt_pk_bf16_f32 v132, v136, v137
v_cvt_pk_bf16_f32 v133, v138, v139
v_cvt_pk_bf16_f32 v134, v140, v141
v_cvt_pk_bf16_f32 v135, v142, v143
v_lshl_or_b32 v16, v244, 15, v128
v_lshl_or_b32 v17, v246, 15, v129
v_lshl_or_b32 v18, v247, 15, v130
v_lshl_or_b32 v19, v249, 15, v131
v_lshl_or_b32 v20, v244, 15, v132
v_lshl_or_b32 v21, v246, 15, v133
v_lshl_or_b32 v22, v247, 15, v134
v_lshl_or_b32 v23, v249, 15, v135
buffer_store_dwordx4 v[16:19], v248, s[20:23], s50 offen offset:0 sc1
buffer_store_dwordx4 v[20:23], v248, s[20:23], s50 offen offset:1024 sc1
ds_write_b128 v6, v[16:19] offset:0
ds_write_b128 v6, v[20:23] offset:1024
v_pk_mul_f32 v[144:145], v[144:145], v[4:5] op_sel_hi:[1,0]
v_pk_mul_f32 v[146:147], v[146:147], v[4:5] op_sel_hi:[1,0]
v_pk_mul_f32 v[148:149], v[148:149], v[4:5] op_sel_hi:[1,0]
v_pk_mul_f32 v[150:151], v[150:151], v[4:5] op_sel_hi:[1,0]
v_pk_mul_f32 v[152:153], v[152:153], v[4:5] op_sel_hi:[1,0]
v_pk_mul_f32 v[154:155], v[154:155], v[4:5] op_sel_hi:[1,0]
v_pk_mul_f32 v[156:157], v[156:157], v[4:5] op_sel_hi:[1,0]
v_pk_mul_f32 v[158:159], v[158:159], v[4:5] op_sel_hi:[1,0]
v_cvt_pk_bf16_f32 v144, v144, v145
v_cvt_pk_bf16_f32 v145, v146, v147
v_cvt_pk_bf16_f32 v146, v148, v149
v_cvt_pk_bf16_f32 v147, v150, v151
v_cvt_pk_bf16_f32 v148, v152, v153
v_cvt_pk_bf16_f32 v149, v154, v155
v_cvt_pk_bf16_f32 v150, v156, v157
v_cvt_pk_bf16_f32 v151, v158, v159
v_lshl_or_b32 v24, v244, 15, v144
v_lshl_or_b32 v25, v246, 15, v145
v_lshl_or_b32 v26, v247, 15, v146
v_lshl_or_b32 v27, v249, 15, v147
v_lshl_or_b32 v28, v244, 15, v148
v_lshl_or_b32 v29, v246, 15, v149
v_lshl_or_b32 v30, v247, 15, v150
v_lshl_or_b32 v31, v249, 15, v151
buffer_store_dwordx4 v[24:27], v248, s[20:23], s51 offen offset:0 sc1
buffer_store_dwordx4 v[28:31], v248, s[20:23], s51 offen offset:1024 sc1
ds_write_b128 v6, v[24:27] offset:2048
ds_write_b128 v6, v[28:31] offset:3072
s_waitcnt lgkmcnt(0)
s_barrier
ds_read_b128 v[152:155], v245 offset:0
ds_read_b128 v[156:159], v245 offset:1024
ds_read_b64_tr_b16 v[136:137], v64 offset:0
ds_read_b64_tr_b16 v[138:139], v64 offset:2048
ds_read_b64_tr_b16 v[140:141], v64 offset:4096
ds_read_b64_tr_b16 v[142:143], v64 offset:6144
ds_read_b64_tr_b16 v[144:145], v65 offset:0
ds_read_b64_tr_b16 v[146:147], v65 offset:2048
ds_read_b64_tr_b16 v[148:149], v65 offset:4096
ds_read_b64_tr_b16 v[150:151], v65 offset:6144
s_mov_b32 s47, 0
s_waitcnt lgkmcnt(8)
v_and_b32 v152, s57, v152
v_and_b32 v153, s57, v153
v_and_b32 v154, s57, v154
v_and_b32 v155, s57, v155
v_and_b32 v156, s57, v156
v_and_b32 v157, s57, v157
v_and_b32 v158, s57, v158
v_and_b32 v159, s57, v159
s_waitcnt lgkmcnt(6)
v_mfma_f32_32x32x16_bf16 v[160:175], v[136:139], v[152:155], 0
s_waitcnt lgkmcnt(4)
v_mfma_f32_32x32x16_bf16 v[160:175], v[140:143], v[156:159], v[160:175]
ds_read_b64_tr_b16 v[136:137], v66 offset:0
ds_read_b64_tr_b16 v[138:139], v66 offset:2048
ds_read_b64_tr_b16 v[140:141], v66 offset:4096
ds_read_b64_tr_b16 v[142:143], v66 offset:6144
s_waitcnt lgkmcnt(6)
v_mfma_f32_32x32x16_bf16 v[176:191], v[144:147], v[152:155], 0
s_waitcnt lgkmcnt(4)
v_mfma_f32_32x32x16_bf16 v[176:191], v[148:151], v[156:159], v[176:191]
ds_read_b64_tr_b16 v[144:145], v67 offset:0
ds_read_b64_tr_b16 v[146:147], v67 offset:2048
ds_read_b64_tr_b16 v[148:149], v67 offset:4096
ds_read_b64_tr_b16 v[150:151], v67 offset:6144
s_nop 1
v_cvt_pk_bf16_f32 v72, v160, v161
v_cvt_pk_bf16_f32 v73, v162, v163
v_cvt_pk_bf16_f32 v74, v164, v165
v_cvt_pk_bf16_f32 v75, v166, v167
v_cvt_pk_bf16_f32 v76, v168, v169
v_cvt_pk_bf16_f32 v77, v170, v171
v_cvt_pk_bf16_f32 v78, v172, v173
v_cvt_pk_bf16_f32 v79, v174, v175
s_waitcnt lgkmcnt(6)
v_mfma_f32_32x32x16_bf16 v[160:175], v[136:139], v[152:155], 0
s_waitcnt lgkmcnt(4)
v_mfma_f32_32x32x16_bf16 v[160:175], v[140:143], v[156:159], v[160:175]
ds_read_b64_tr_b16 v[192:193], v68 offset:0
ds_read_b64_tr_b16 v[194:195], v68 offset:2048
ds_read_b64_tr_b16 v[196:197], v242 offset:0
ds_read_b64_tr_b16 v[198:199], v242 offset:1024
ds_read_b64_tr_b16 v[200:201], v243 offset:0
ds_read_b64_tr_b16 v[202:203], v243 offset:1024
ds_read_b64_tr_b16 v[204:205], v69 offset:0
ds_read_b64_tr_b16 v[206:207], v69 offset:2048
s_nop 3
v_cvt_pk_bf16_f32 v80, v176, v177
v_cvt_pk_bf16_f32 v81, v178, v179
v_cvt_pk_bf16_f32 v82, v180, v181
v_cvt_pk_bf16_f32 v83, v182, v183
v_cvt_pk_bf16_f32 v84, v184, v185
v_cvt_pk_bf16_f32 v85, v186, v187
v_cvt_pk_bf16_f32 v86, v188, v189
v_cvt_pk_bf16_f32 v87, v190, v191
s_waitcnt lgkmcnt(8)
v_mfma_f32_32x32x16_bf16 v[176:191], v[144:147], v[152:155], 0
v_mfma_f32_32x32x16_bf16 v[176:191], v[148:151], v[156:159], v[176:191]
v_cvt_pk_bf16_f32 v88, v160, v161
v_cvt_pk_bf16_f32 v89, v162, v163
v_cvt_pk_bf16_f32 v90, v164, v165
v_cvt_pk_bf16_f32 v91, v166, v167
v_cvt_pk_bf16_f32 v92, v168, v169
v_cvt_pk_bf16_f32 v93, v170, v171
v_cvt_pk_bf16_f32 v94, v172, v173
v_cvt_pk_bf16_f32 v95, v174, v175
s_nop 3
s_waitcnt lgkmcnt(0)
v_mfma_f32_32x32x16_bf16 v[0:15], v[192:195], v[72:75], 0
ds_read_b64_tr_b16 v[192:193], v242 offset:2048
ds_read_b64_tr_b16 v[194:195], v242 offset:3072
v_cvt_pk_bf16_f32 v96, v176, v177
v_cvt_pk_bf16_f32 v97, v178, v179
v_mfma_f32_32x32x16_bf16 v[208:223], v[196:199], v[72:75], 0
ds_read_b64_tr_b16 v[196:197], v243 offset:2048
ds_read_b64_tr_b16 v[198:199], v243 offset:3072
v_cvt_pk_bf16_f32 v98, v180, v181
v_cvt_pk_bf16_f32 v99, v182, v183
v_mfma_f32_32x32x16_bf16 v[224:239], v[200:203], v[72:75], 0
ds_read_b64_tr_b16 v[200:201], v70 offset:0
ds_read_b64_tr_b16 v[202:203], v70 offset:2048
v_cvt_pk_bf16_f32 v100, v184, v185
v_cvt_pk_bf16_f32 v101, v186, v187
v_mfma_f32_32x32x16_bf16 v[16:31], v[204:207], v[72:75], 0
ds_read_b64_tr_b16 v[204:205], v242 offset:4096
ds_read_b64_tr_b16 v[206:207], v242 offset:5120
v_cvt_pk_bf16_f32 v102, v188, v189
s_waitcnt lgkmcnt(4)
v_mfma_f32_32x32x16_bf16 v[208:223], v[192:195], v[76:79], v[208:223]
ds_read_b64_tr_b16 v[192:193], v243 offset:4096
ds_read_b64_tr_b16 v[194:195], v243 offset:5120
v_cvt_pk_bf16_f32 v103, v190, v191
v_mfma_f32_32x32x16_bf16 v[224:239], v[196:199], v[76:79], v[224:239]
ds_read_b64_tr_b16 v[196:197], v71 offset:0
ds_read_b64_tr_b16 v[198:199], v71 offset:2048
s_waitcnt lgkmcnt(4)
v_mfma_f32_32x32x16_bf16 v[32:47], v[200:203], v[72:75], 0
ds_read_b64_tr_b16 v[200:201], v242 offset:6144
ds_read_b64_tr_b16 v[202:203], v242 offset:7168
v_mfma_f32_32x32x16_bf16 v[208:223], v[204:207], v[80:83], v[208:223]
ds_read_b64_tr_b16 v[204:205], v243 offset:6144
ds_read_b64_tr_b16 v[206:207], v243 offset:7168
s_waitcnt lgkmcnt(4)
v_mfma_f32_32x32x16_bf16 v[224:239], v[192:195], v[80:83], v[224:239]
ds_read_b64_tr_b16 v[192:193], v68 offset:4096
ds_read_b64_tr_b16 v[194:195], v68 offset:6144
v_mfma_f32_32x32x16_bf16 v[48:63], v[196:199], v[72:75], 0
ds_read_b64_tr_b16 v[196:197], v242 offset:8192
ds_read_b64_tr_b16 v[198:199], v242 offset:9216
s_waitcnt lgkmcnt(4)
v_mfma_f32_32x32x16_bf16 v[208:223], v[200:203], v[84:87], v[208:223]
ds_read_b64_tr_b16 v[200:201], v243 offset:8192
ds_read_b64_tr_b16 v[202:203], v243 offset:9216
v_mfma_f32_32x32x16_bf16 v[224:239], v[204:207], v[84:87], v[224:239]
ds_read_b64_tr_b16 v[204:205], v69 offset:4096
ds_read_b64_tr_b16 v[206:207], v69 offset:6144
s_waitcnt lgkmcnt(4)
v_mfma_f32_32x32x16_bf16 v[0:15], v[192:195], v[76:79], v[0:15]
ds_read_b64_tr_b16 v[192:193], v242 offset:10240
ds_read_b64_tr_b16 v[194:195], v242 offset:11264
v_mfma_f32_32x32x16_bf16 v[208:223], v[196:199], v[88:91], v[208:223]
ds_read_b64_tr_b16 v[196:197], v243 offset:10240
ds_read_b64_tr_b16 v[198:199], v243 offset:11264
s_waitcnt lgkmcnt(4)
v_mfma_f32_32x32x16_bf16 v[224:239], v[200:203], v[88:91], v[224:239]
ds_read_b64_tr_b16 v[200:201], v70 offset:4096
ds_read_b64_tr_b16 v[202:203], v70 offset:6144
v_mfma_f32_32x32x16_bf16 v[16:31], v[204:207], v[76:79], v[16:31]
ds_read_b64_tr_b16 v[204:205], v242 offset:12288
ds_read_b64_tr_b16 v[206:207], v242 offset:13312
s_waitcnt lgkmcnt(4)
v_mfma_f32_32x32x16_bf16 v[208:223], v[192:195], v[92:95], v[208:223]
ds_read_b64_tr_b16 v[192:193], v243 offset:12288
ds_read_b64_tr_b16 v[194:195], v243 offset:13312
v_mfma_f32_32x32x16_bf16 v[224:239], v[196:199], v[92:95], v[224:239]
ds_read_b64_tr_b16 v[196:197], v71 offset:4096
ds_read_b64_tr_b16 v[198:199], v71 offset:6144
s_waitcnt lgkmcnt(4)
v_mfma_f32_32x32x16_bf16 v[32:47], v[200:203], v[76:79], v[32:47]
ds_read_b64_tr_b16 v[200:201], v242 offset:14336
ds_read_b64_tr_b16 v[202:203], v242 offset:15360
v_mfma_f32_32x32x16_bf16 v[208:223], v[204:207], v[96:99], v[208:223]
ds_read_b64_tr_b16 v[204:205], v243 offset:14336
ds_read_b64_tr_b16 v[206:207], v243 offset:15360
s_waitcnt lgkmcnt(4)
v_mfma_f32_32x32x16_bf16 v[224:239], v[192:195], v[96:99], v[224:239]
ds_read_b64_tr_b16 v[192:193], v68 offset:8192
ds_read_b64_tr_b16 v[194:195], v68 offset:10240
v_mfma_f32_32x32x16_bf16 v[48:63], v[196:199], v[76:79], v[48:63]
ds_read_b64_tr_b16 v[196:197], v69 offset:8192
ds_read_b64_tr_b16 v[198:199], v69 offset:10240
s_waitcnt lgkmcnt(4)
v_mfma_f32_32x32x16_bf16 v[208:223], v[200:203], v[100:103], v[208:223]
ds_read_b64_tr_b16 v[200:201], v70 offset:8192
ds_read_b64_tr_b16 v[202:203], v70 offset:10240
v_mfma_f32_32x32x16_bf16 v[224:239], v[204:207], v[100:103], v[224:239]
ds_read_b64_tr_b16 v[204:205], v71 offset:8192
ds_read_b64_tr_b16 v[206:207], v71 offset:10240
s_waitcnt lgkmcnt(4)
v_mfma_f32_32x32x16_bf16 v[0:15], v[192:195], v[80:83], v[0:15]
ds_read_b64_tr_b16 v[192:193], v68 offset:12288
ds_read_b64_tr_b16 v[194:195], v68 offset:14336
v_mfma_f32_32x32x16_bf16 v[16:31], v[196:199], v[80:83], v[16:31]
s_barrier
ds_read_b64_tr_b16 v[196:197], v69 offset:12288
ds_read_b64_tr_b16 v[198:199], v69 offset:14336
ds_read_b128 v[152:155], v245 offset:8192
ds_read_b128 v[156:159], v245 offset:9216
s_waitcnt lgkmcnt(6)
v_mfma_f32_32x32x16_bf16 v[32:47], v[200:203], v[80:83], v[32:47]
ds_read_b64_tr_b16 v[200:201], v70 offset:12288
ds_read_b64_tr_b16 v[202:203], v70 offset:14336
ds_read_b64_tr_b16 v[136:137], v64 offset:32768
v_mfma_f32_32x32x16_bf16 v[48:63], v[204:207], v[80:83], v[48:63]
ds_read_b64_tr_b16 v[204:205], v71 offset:12288
ds_read_b64_tr_b16 v[206:207], v71 offset:14336
ds_read_b64_tr_b16 v[138:139], v64 offset:34816
ds_read_b64_tr_b16 v[140:141], v64 offset:36864
ds_read_b64_tr_b16 v[142:143], v64 offset:38912
s_waitcnt lgkmcnt(8)
v_mfma_f32_32x32x16_bf16 v[0:15], v[192:195], v[84:87], v[0:15]
v_and_b32 v152, s57, v152
v_and_b32 v153, s57, v153
v_and_b32 v154, s57, v154
v_and_b32 v155, s57, v155
ds_read_b64_tr_b16 v[192:193], v68 offset:16384
v_mfma_f32_32x32x16_bf16 v[16:31], v[196:199], v[84:87], v[16:31]
ds_read_b64_tr_b16 v[194:195], v68 offset:18432
ds_read_b64_tr_b16 v[196:197], v69 offset:16384
v_and_b32 v156, s57, v156
s_waitcnt lgkmcnt(3)
v_mfma_f32_32x32x16_bf16 v[32:47], v[200:203], v[84:87], v[32:47]
ds_read_b64_tr_b16 v[198:199], v69 offset:18432
v_and_b32 v157, s57, v157
v_and_b32 v158, s57, v158
v_and_b32 v159, s57, v159
v_mfma_f32_32x32x16_bf16 v[160:175], v[136:139], v[152:155], 0
ds_read_b64_tr_b16 v[144:145], v65 offset:32768
ds_read_b64_tr_b16 v[146:147], v65 offset:34816
ds_read_b64_tr_b16 v[200:201], v70 offset:16384
v_mfma_f32_32x32x16_bf16 v[48:63], v[204:207], v[84:87], v[48:63]
ds_read_b64_tr_b16 v[202:203], v70 offset:18432
ds_read_b64_tr_b16 v[204:205], v71 offset:16384
ds_read_b64_tr_b16 v[206:207], v71 offset:18432
v_mfma_f32_32x32x16_bf16 v[160:175], v[140:143], v[156:159], v[160:175]
ds_read_b64_tr_b16 v[148:149], v65 offset:36864
ds_read_b64_tr_b16 v[150:151], v65 offset:38912
s_waitcnt lgkmcnt(5)
v_mfma_f32_32x32x16_bf16 v[0:15], v[192:195], v[88:91], v[0:15]
ds_read_b64_tr_b16 v[192:193], v68 offset:20480
ds_read_b64_tr_b16 v[194:195], v68 offset:22528
ds_read_b64_tr_b16 v[136:137], v66 offset:32768
v_mfma_f32_32x32x16_bf16 v[16:31], v[196:199], v[88:91], v[16:31]
ds_read_b64_tr_b16 v[196:197], v69 offset:20480
ds_read_b64_tr_b16 v[198:199], v69 offset:22528
ds_read_b64_tr_b16 v[138:139], v66 offset:34816
v_mfma_f32_32x32x16_bf16 v[176:191], v[144:147], v[152:155], 0
ds_read_b64_tr_b16 v[140:141], v66 offset:36864
ds_read_b64_tr_b16 v[142:143], v66 offset:38912
s_waitcnt lgkmcnt(5)
v_mfma_f32_32x32x16_bf16 v[32:47], v[200:203], v[88:91], v[32:47]
ds_read_b64_tr_b16 v[200:201], v70 offset:20480
ds_read_b64_tr_b16 v[202:203], v70 offset:22528
ds_read_b64_tr_b16 v[144:145], v67 offset:32768
v_mfma_f32_32x32x16_bf16 v[48:63], v[204:207], v[88:91], v[48:63]
ds_read_b64_tr_b16 v[204:205], v71 offset:20480
ds_read_b64_tr_b16 v[206:207], v71 offset:22528
v_cvt_pk_bf16_f32 v104, v160, v161
v_cvt_pk_bf16_f32 v105, v162, v163
v_mfma_f32_32x32x16_bf16 v[176:191], v[148:151], v[156:159], v[176:191]
v_cvt_pk_bf16_f32 v106, v164, v165
v_cvt_pk_bf16_f32 v107, v166, v167
v_cvt_pk_bf16_f32 v108, v168, v169
v_cvt_pk_bf16_f32 v109, v170, v171
v_cvt_pk_bf16_f32 v110, v172, v173
v_cvt_pk_bf16_f32 v111, v174, v175
v_mfma_f32_32x32x16_bf16 v[0:15], v[192:195], v[92:95], v[0:15]
ds_read_b64_tr_b16 v[192:193], v68 offset:24576
ds_read_b64_tr_b16 v[194:195], v68 offset:26624
s_waitcnt lgkmcnt(2)
v_mfma_f32_32x32x16_bf16 v[16:31], v[196:199], v[92:95], v[16:31]
ds_read_b64_tr_b16 v[196:197], v69 offset:24576
ds_read_b64_tr_b16 v[198:199], v69 offset:26624
ds_read_b64_tr_b16 v[146:147], v67 offset:34816
v_mfma_f32_32x32x16_bf16 v[32:47], v[200:203], v[92:95], v[32:47]
ds_read_b64_tr_b16 v[200:201], v70 offset:24576
ds_read_b64_tr_b16 v[202:203], v70 offset:26624
ds_read_b64_tr_b16 v[148:149], v67 offset:36864
v_mfma_f32_32x32x16_bf16 v[160:175], v[136:139], v[152:155], 0
ds_read_b64_tr_b16 v[150:151], v67 offset:38912
v_mfma_f32_32x32x16_bf16 v[48:63], v[204:207], v[92:95], v[48:63]
ds_read_b64_tr_b16 v[204:205], v71 offset:24576
ds_read_b64_tr_b16 v[206:207], v71 offset:26624
v_cvt_pk_bf16_f32 v112, v176, v177
v_cvt_pk_bf16_f32 v113, v178, v179
v_mfma_f32_32x32x16_bf16 v[160:175], v[140:143], v[156:159], v[160:175]
v_cvt_pk_bf16_f32 v114, v180, v181
v_cvt_pk_bf16_f32 v115, v182, v183
v_cvt_pk_bf16_f32 v116, v184, v185
v_cvt_pk_bf16_f32 v117, v186, v187
v_cvt_pk_bf16_f32 v118, v188, v189
s_waitcnt lgkmcnt(2)
v_mfma_f32_32x32x16_bf16 v[0:15], v[192:195], v[96:99], v[0:15]
ds_read_b64_tr_b16 v[192:193], v68 offset:28672
ds_read_b64_tr_b16 v[194:195], v68 offset:30720
v_cvt_pk_bf16_f32 v119, v190, v191
v_mfma_f32_32x32x16_bf16 v[16:31], v[196:199], v[96:99], v[16:31]
ds_read_b64_tr_b16 v[196:197], v69 offset:28672
ds_read_b64_tr_b16 v[198:199], v69 offset:30720
v_mfma_f32_32x32x16_bf16 v[32:47], v[200:203], v[96:99], v[32:47]
ds_read_b64_tr_b16 v[200:201], v70 offset:28672
ds_read_b64_tr_b16 v[202:203], v70 offset:30720
v_mfma_f32_32x32x16_bf16 v[176:191], v[144:147], v[152:155], 0
s_waitcnt lgkmcnt(2)
v_mfma_f32_32x32x16_bf16 v[48:63], v[204:207], v[96:99], v[48:63]
s_barrier
ds_read_b64_tr_b16 v[204:205], v71 offset:28672
ds_read_b64_tr_b16 v[206:207], v71 offset:30720
v_cvt_pk_bf16_f32 v120, v160, v161
v_mfma_f32_32x32x16_bf16 v[0:15], v[192:195], v[100:103], v[0:15]
ds_read_b64_tr_b16 v[192:193], v68 offset:32768
ds_read_b64_tr_b16 v[194:195], v68 offset:34816
v_cvt_pk_bf16_f32 v121, v162, v163
v_cvt_pk_bf16_f32 v122, v164, v165
v_mfma_f32_32x32x16_bf16 v[176:191], v[148:151], v[156:159], v[176:191]
v_cvt_pk_bf16_f32 v123, v166, v167
v_cvt_pk_bf16_f32 v124, v168, v169
v_cvt_pk_bf16_f32 v125, v170, v171
v_cvt_pk_bf16_f32 v126, v172, v173
v_cvt_pk_bf16_f32 v127, v174, v175
v_mfma_f32_32x32x16_bf16 v[16:31], v[196:199], v[100:103], v[16:31]
ds_read_b64_tr_b16 v[196:197], v69 offset:32768
ds_read_b64_tr_b16 v[198:199], v69 offset:34816
s_waitcnt lgkmcnt(2)
v_mfma_f32_32x32x16_bf16 v[32:47], v[200:203], v[100:103], v[32:47]
ds_read_b64_tr_b16 v[200:201], v70 offset:32768
ds_read_b64_tr_b16 v[202:203], v70 offset:34816
v_mfma_f32_32x32x16_bf16 v[48:63], v[204:207], v[100:103], v[48:63]
ds_read_b64_tr_b16 v[204:205], v71 offset:32768
ds_read_b64_tr_b16 v[206:207], v71 offset:34816
v_mfma_f32_32x32x16_bf16 v[0:15], v[192:195], v[104:107], v[0:15]
ds_read_b64_tr_b16 v[192:193], v68 offset:36864
ds_read_b64_tr_b16 v[194:195], v68 offset:38912
v_cvt_pk_bf16_f32 v128, v176, v177
s_waitcnt lgkmcnt(4)
v_mfma_f32_32x32x16_bf16 v[16:31], v[196:199], v[104:107], v[16:31]
ds_read_b64_tr_b16 v[196:197], v69 offset:36864
ds_read_b64_tr_b16 v[198:199], v69 offset:38912
v_cvt_pk_bf16_f32 v129, v178, v179
v_cvt_pk_bf16_f32 v130, v180, v181
v_mfma_f32_32x32x16_bf16 v[32:47], v[200:203], v[104:107], v[32:47]
ds_read_b64_tr_b16 v[200:201], v70 offset:36864
ds_read_b64_tr_b16 v[202:203], v70 offset:38912
v_cvt_pk_bf16_f32 v131, v182, v183
s_waitcnt lgkmcnt(4)
v_mfma_f32_32x32x16_bf16 v[48:63], v[204:207], v[104:107], v[48:63]
ds_read_b64_tr_b16 v[204:205], v71 offset:36864
ds_read_b64_tr_b16 v[206:207], v71 offset:38912
v_cvt_pk_bf16_f32 v132, v184, v185
v_cvt_pk_bf16_f32 v133, v186, v187
v_mfma_f32_32x32x16_bf16 v[0:15], v[192:195], v[108:111], v[0:15]
ds_read_b64_tr_b16 v[192:193], v68 offset:40960
ds_read_b64_tr_b16 v[194:195], v68 offset:43008
v_cvt_pk_bf16_f32 v134, v188, v189
s_waitcnt lgkmcnt(4)
v_mfma_f32_32x32x16_bf16 v[16:31], v[196:199], v[108:111], v[16:31]
ds_read_b64_tr_b16 v[196:197], v69 offset:40960
ds_read_b64_tr_b16 v[198:199], v69 offset:43008
v_cvt_pk_bf16_f32 v135, v190, v191
v_mfma_f32_32x32x16_bf16 v[32:47], v[200:203], v[108:111], v[32:47]
ds_read_b64_tr_b16 v[200:201], v70 offset:40960
ds_read_b64_tr_b16 v[202:203], v70 offset:43008
s_waitcnt lgkmcnt(4)
v_mfma_f32_32x32x16_bf16 v[48:63], v[204:207], v[108:111], v[48:63]
ds_read_b64_tr_b16 v[204:205], v71 offset:40960
ds_read_b64_tr_b16 v[206:207], v71 offset:43008
v_mfma_f32_32x32x16_bf16 v[0:15], v[192:195], v[112:115], v[0:15]
s_barrier
ds_read_b64_tr_b16 v[192:193], v242 offset:0
ds_read_b64_tr_b16 v[194:195], v242 offset:1024
s_waitcnt lgkmcnt(4)
v_mfma_f32_32x32x16_bf16 v[16:31], v[196:199], v[112:115], v[16:31]
ds_read_b64_tr_b16 v[196:197], v243 offset:0
ds_read_b64_tr_b16 v[198:199], v243 offset:1024
v_mfma_f32_32x32x16_bf16 v[32:47], v[200:203], v[112:115], v[32:47]
ds_read_b64_tr_b16 v[200:201], v242 offset:2048
ds_read_b64_tr_b16 v[202:203], v242 offset:3072
s_waitcnt lgkmcnt(4)
v_mfma_f32_32x32x16_bf16 v[48:63], v[204:207], v[112:115], v[48:63]
ds_read_b64_tr_b16 v[204:205], v243 offset:2048
ds_read_b64_tr_b16 v[206:207], v243 offset:3072
v_mfma_f32_32x32x16_bf16 v[208:223], v[192:195], v[104:107], v[208:223]
ds_read_b64_tr_b16 v[192:193], v242 offset:4096
ds_read_b64_tr_b16 v[194:195], v242 offset:5120
s_waitcnt lgkmcnt(4)
v_mfma_f32_32x32x16_bf16 v[224:239], v[196:199], v[104:107], v[224:239]
ds_read_b64_tr_b16 v[196:197], v243 offset:4096
ds_read_b64_tr_b16 v[198:199], v243 offset:5120
v_mfma_f32_32x32x16_bf16 v[208:223], v[200:203], v[108:111], v[208:223]
ds_read_b64_tr_b16 v[200:201], v242 offset:6144
ds_read_b64_tr_b16 v[202:203], v242 offset:7168
s_waitcnt lgkmcnt(4)
v_mfma_f32_32x32x16_bf16 v[224:239], v[204:207], v[108:111], v[224:239]
ds_read_b64_tr_b16 v[204:205], v243 offset:6144
ds_read_b64_tr_b16 v[206:207], v243 offset:7168
v_mfma_f32_32x32x16_bf16 v[208:223], v[192:195], v[112:115], v[208:223]
ds_read_b64_tr_b16 v[192:193], v242 offset:8192
ds_read_b64_tr_b16 v[194:195], v242 offset:9216
s_waitcnt lgkmcnt(4)
v_mfma_f32_32x32x16_bf16 v[224:239], v[196:199], v[112:115], v[224:239]
ds_read_b64_tr_b16 v[196:197], v243 offset:8192
ds_read_b64_tr_b16 v[198:199], v243 offset:9216
v_mfma_f32_32x32x16_bf16 v[208:223], v[200:203], v[116:119], v[208:223]
ds_read_b64_tr_b16 v[200:201], v242 offset:10240
ds_read_b64_tr_b16 v[202:203], v242 offset:11264
s_waitcnt lgkmcnt(4)
v_mfma_f32_32x32x16_bf16 v[224:239], v[204:207], v[116:119], v[224:239]
ds_read_b64_tr_b16 v[204:205], v243 offset:10240
ds_read_b64_tr_b16 v[206:207], v243 offset:11264
v_mfma_f32_32x32x16_bf16 v[208:223], v[192:195], v[120:123], v[208:223]
ds_read_b64_tr_b16 v[192:193], v242 offset:12288
ds_read_b64_tr_b16 v[194:195], v242 offset:13312
s_waitcnt lgkmcnt(4)
v_mfma_f32_32x32x16_bf16 v[224:239], v[196:199], v[120:123], v[224:239]
ds_read_b64_tr_b16 v[196:197], v243 offset:12288
ds_read_b64_tr_b16 v[198:199], v243 offset:13312
v_mfma_f32_32x32x16_bf16 v[208:223], v[200:203], v[124:127], v[208:223]
ds_read_b64_tr_b16 v[200:201], v242 offset:14336
ds_read_b64_tr_b16 v[202:203], v242 offset:15360
s_waitcnt lgkmcnt(4)
v_mfma_f32_32x32x16_bf16 v[224:239], v[204:207], v[124:127], v[224:239]
ds_read_b64_tr_b16 v[204:205], v243 offset:14336
ds_read_b64_tr_b16 v[206:207], v243 offset:15360
v_mfma_f32_32x32x16_bf16 v[208:223], v[192:195], v[128:131], v[208:223]
ds_read_b64_tr_b16 v[192:193], v68 offset:45056
ds_read_b64_tr_b16 v[194:195], v68 offset:47104
s_waitcnt lgkmcnt(4)
v_mfma_f32_32x32x16_bf16 v[224:239], v[196:199], v[128:131], v[224:239]
s_barrier
ds_read_b64_tr_b16 v[196:197], v69 offset:45056
ds_read_b64_tr_b16 v[198:199], v69 offset:47104
ds_read_b128 v[152:155], v245 offset:0
ds_read_b128 v[156:159], v245 offset:1024
v_mfma_f32_32x32x16_bf16 v[208:223], v[200:203], v[132:135], v[208:223]
ds_read_b64_tr_b16 v[200:201], v70 offset:45056
ds_read_b64_tr_b16 v[202:203], v70 offset:47104
s_waitcnt lgkmcnt(6)
v_mfma_f32_32x32x16_bf16 v[224:239], v[204:207], v[132:135], v[224:239]
ds_read_b64_tr_b16 v[204:205], v71 offset:45056
ds_read_b64_tr_b16 v[206:207], v71 offset:47104
ds_read_b64_tr_b16 v[136:137], v64 offset:0
ds_read_b64_tr_b16 v[138:139], v64 offset:2048
ds_read_b64_tr_b16 v[140:141], v64 offset:4096
ds_read_b64_tr_b16 v[142:143], v64 offset:6144
v_mfma_f32_32x32x16_bf16 v[0:15], v[192:195], v[116:119], v[0:15]
s_waitcnt lgkmcnt(6)
v_and_b32 v152, s57, v152
v_and_b32 v153, s57, v153
v_and_b32 v154, s57, v154
v_and_b32 v155, s57, v155
v_and_b32 v156, s57, v156
v_mfma_f32_32x32x16_bf16 v[16:31], v[196:199], v[116:119], v[16:31]
ds_read_b64_tr_b16 v[192:193], v68 offset:49152
ds_read_b64_tr_b16 v[194:195], v68 offset:51200
ds_read_b64_tr_b16 v[196:197], v69 offset:49152
v_mfma_f32_32x32x16_bf16 v[32:47], v[200:203], v[116:119], v[32:47]
ds_read_b64_tr_b16 v[198:199], v69 offset:51200
v_and_b32 v157, s57, v157
v_and_b32 v158, s57, v158
v_and_b32 v159, s57, v159
s_waitcnt lgkmcnt(4)
v_mfma_f32_32x32x16_bf16 v[160:175], v[136:139], v[152:155], 0
ds_read_b64_tr_b16 v[144:145], v65 offset:0
ds_read_b64_tr_b16 v[146:147], v65 offset:2048
v_cvt_pk_bf16_f32 v224, v224, v225
v_cvt_pk_bf16_f32 v225, v226, v227
v_mfma_f32_32x32x16_bf16 v[48:63], v[204:207], v[116:119], v[48:63]
ds_read_b64_tr_b16 v[200:201], v70 offset:49152
ds_read_b64_tr_b16 v[202:203], v70 offset:51200
ds_read_b64_tr_b16 v[204:205], v71 offset:49152
v_mfma_f32_32x32x16_bf16 v[160:175], v[140:143], v[156:159], v[160:175]
ds_read_b64_tr_b16 v[206:207], v71 offset:51200
ds_read_b64_tr_b16 v[148:149], v65 offset:4096
v_cvt_pk_bf16_f32 v226, v228, v229
s_waitcnt lgkmcnt(5)
v_mfma_f32_32x32x16_bf16 v[0:15], v[192:195], v[120:123], v[0:15]
ds_read_b64_tr_b16 v[150:151], v65 offset:6144
v_cvt_pk_bf16_f32 v227, v230, v231
v_cvt_pk_bf16_f32 v228, v232, v233
ds_read_b64_tr_b16 v[192:193], v68 offset:53248
v_mfma_f32_32x32x16_bf16 v[16:31], v[196:199], v[120:123], v[16:31]
ds_read_b64_tr_b16 v[194:195], v68 offset:55296
ds_read_b64_tr_b16 v[196:197], v69 offset:53248
ds_read_b64_tr_b16 v[198:199], v69 offset:55296
v_mfma_f32_32x32x16_bf16 v[176:191], v[144:147], v[152:155], 0
v_cvt_pk_bf16_f32 v229, v234, v235
v_cvt_pk_bf16_f32 v230, v236, v237
ds_read_b64_tr_b16 v[136:137], v66 offset:0
v_cvt_pk_bf16_f32 v231, v238, v239
s_waitcnt lgkmcnt(4)
v_mfma_f32_32x32x16_bf16 v[32:47], v[200:203], v[120:123], v[32:47]
ds_read_b64_tr_b16 v[200:201], v70 offset:53248
ds_read_b64_tr_b16 v[202:203], v70 offset:55296
ds_read_b64_tr_b16 v[138:139], v66 offset:2048
v_mfma_f32_32x32x16_bf16 v[176:191], v[148:151], v[156:159], v[176:191]
ds_read_b64_tr_b16 v[140:141], v66 offset:4096
ds_read_b64_tr_b16 v[142:143], v66 offset:6144
v_cvt_pk_bf16_f32 v232, v208, v209
v_cvt_pk_bf16_f32 v233, v210, v211
v_mfma_f32_32x32x16_bf16 v[48:63], v[204:207], v[120:123], v[48:63]
ds_read_b64_tr_b16 v[204:205], v71 offset:53248
ds_read_b64_tr_b16 v[206:207], v71 offset:55296
v_cvt_pk_bf16_f32 v72, v160, v161
s_waitcnt lgkmcnt(4)
v_mfma_f32_32x32x16_bf16 v[0:15], v[192:195], v[124:127], v[0:15]
v_cvt_pk_bf16_f32 v73, v162, v163
v_cvt_pk_bf16_f32 v74, v164, v165
v_cvt_pk_bf16_f32 v75, v166, v167
v_cvt_pk_bf16_f32 v76, v168, v169
v_cvt_pk_bf16_f32 v77, v170, v171
v_cvt_pk_bf16_f32 v78, v172, v173
v_mfma_f32_32x32x16_bf16 v[16:31], v[196:199], v[124:127], v[16:31]
v_cvt_pk_bf16_f32 v79, v174, v175
v_cvt_pk_bf16_f32 v234, v212, v213
ds_read_b64_tr_b16 v[192:193], v68 offset:57344
ds_read_b64_tr_b16 v[194:195], v68 offset:59392
v_mfma_f32_32x32x16_bf16 v[32:47], v[200:203], v[124:127], v[32:47]
ds_read_b64_tr_b16 v[196:197], v69 offset:57344
ds_read_b64_tr_b16 v[198:199], v69 offset:59392
v_cvt_pk_bf16_f32 v235, v214, v215
v_cvt_pk_bf16_f32 v236, v216, v217
v_mfma_f32_32x32x16_bf16 v[160:175], v[136:139], v[152:155], 0
ds_read_b64_tr_b16 v[200:201], v70 offset:57344
ds_read_b64_tr_b16 v[202:203], v70 offset:59392
v_cvt_pk_bf16_f32 v237, v218, v219
s_waitcnt lgkmcnt(4)
v_mfma_f32_32x32x16_bf16 v[48:63], v[204:207], v[124:127], v[48:63]
ds_read_b64_tr_b16 v[204:205], v71 offset:57344
ds_read_b64_tr_b16 v[206:207], v71 offset:59392
ds_read_b64_tr_b16 v[144:145], v67 offset:0
v_mfma_f32_32x32x16_bf16 v[160:175], v[140:143], v[156:159], v[160:175]
ds_read_b64_tr_b16 v[146:147], v67 offset:2048
ds_read_b64_tr_b16 v[148:149], v67 offset:4096
ds_read_b64_tr_b16 v[150:151], v67 offset:6144
v_mfma_f32_32x32x16_bf16 v[0:15], v[192:195], v[128:131], v[0:15]
v_cvt_pk_bf16_f32 v238, v220, v221
v_cvt_pk_bf16_f32 v239, v222, v223
ds_read_b64_tr_b16 v[192:193], v68 offset:61440
v_cvt_pk_bf16_f32 v80, v176, v177
s_waitcnt lgkmcnt(4)
v_mfma_f32_32x32x16_bf16 v[16:31], v[196:199], v[128:131], v[16:31]
ds_read_b64_tr_b16 v[194:195], v68 offset:63488
ds_read_b64_tr_b16 v[196:197], v69 offset:61440
ds_read_b64_tr_b16 v[198:199], v69 offset:63488
v_mfma_f32_32x32x16_bf16 v[32:47], v[200:203], v[128:131], v[32:47]
v_cvt_pk_bf16_f32 v81, v178, v179
v_cvt_pk_bf16_f32 v82, v180, v181
v_cvt_pk_bf16_f32 v83, v182, v183
v_cvt_pk_bf16_f32 v84, v184, v185
v_cvt_pk_bf16_f32 v85, v186, v187
v_cvt_pk_bf16_f32 v86, v188, v189
v_cvt_pk_bf16_f32 v87, v190, v191
s_waitcnt lgkmcnt(3)
v_mfma_f32_32x32x16_bf16 v[176:191], v[144:147], v[152:155], 0
ds_read_b64_tr_b16 v[200:201], v70 offset:61440
ds_read_b64_tr_b16 v[202:203], v70 offset:63488
v_and_or_b32 v224, v224, s73, v244
v_and_or_b32 v225, v225, s73, v246
v_mfma_f32_32x32x16_bf16 v[48:63], v[204:207], v[128:131], v[48:63]
s_barrier
ds_read_b64_tr_b16 v[204:205], v71 offset:61440
ds_read_b64_tr_b16 v[206:207], v71 offset:63488
s_waitcnt lgkmcnt(4)
v_mfma_f32_32x32x16_bf16 v[0:15], v[192:195], v[132:135], v[0:15]
ds_read_b64_tr_b16 v[192:193], v68 offset:0
ds_read_b64_tr_b16 v[194:195], v68 offset:2048
v_and_or_b32 v226, v226, s73, v247
v_and_or_b32 v227, v227, s73, v249
v_mfma_f32_32x32x16_bf16 v[176:191], v[148:151], v[156:159], v[176:191]
v_and_or_b32 v228, v228, s73, v244
v_and_or_b32 v229, v229, s73, v246
v_and_or_b32 v230, v230, s73, v247
v_and_or_b32 v231, v231, s73, v249
v_and_or_b32 v232, v232, s73, v244
v_and_or_b32 v233, v233, s73, v246
v_mfma_f32_32x32x16_bf16 v[16:31], v[196:199], v[132:135], v[16:31]
ds_read_b64_tr_b16 v[196:197], v69 offset:0
ds_read_b64_tr_b16 v[198:199], v69 offset:2048
v_and_or_b32 v234, v234, s73, v247
s_waitcnt lgkmcnt(2)
v_mfma_f32_32x32x16_bf16 v[32:47], v[200:203], v[132:135], v[32:47]
ds_read_b64_tr_b16 v[200:201], v70 offset:0
ds_read_b64_tr_b16 v[202:203], v70 offset:2048
v_and_or_b32 v235, v235, s73, v249
v_and_or_b32 v236, v236, s73, v244
v_and_or_b32 v237, v237, s73, v246
v_and_or_b32 v238, v238, s73, v247
v_and_or_b32 v239, v239, s73, v249
v_mfma_f32_32x32x16_bf16 v[48:63], v[204:207], v[132:135], v[48:63]
ds_read_b64_tr_b16 v[204:205], v71 offset:0
ds_read_b64_tr_b16 v[206:207], v71 offset:2048
v_cvt_pk_bf16_f32 v88, v160, v161
v_cvt_pk_bf16_f32 v89, v162, v163
v_cvt_pk_bf16_f32 v90, v164, v165
v_cvt_pk_bf16_f32 v91, v166, v167
v_cvt_pk_bf16_f32 v92, v168, v169
v_cvt_pk_bf16_f32 v93, v170, v171
v_cvt_pk_bf16_f32 v94, v172, v173
v_cvt_pk_bf16_f32 v95, v174, v175
buffer_store_dwordx4 v[232:235], v248, s[20:23], s79 offen sc1
buffer_store_dwordx4 v[236:239], v248, s[20:23], s83 offen sc1
buffer_store_dwordx4 v[224:227], v248, s[20:23], s84 offen sc1
buffer_store_dwordx4 v[228:231], v248, s[20:23], s85 offen sc1
L_p2:
s_waitcnt lgkmcnt(4)
v_mfma_f32_32x32x16_bf16 v[0:15], v[192:195], v[72:75], v[0:15]
ds_read_b64_tr_b16 v[208:209], v68 offset:4096
ds_read_b64_tr_b16 v[210:211], v68 offset:6144
ds_read_b64_tr_b16 v[212:213], v69 offset:4096
v_mfma_f32_32x32x16_bf16 v[16:31], v[196:199], v[72:75], v[16:31]
ds_read_b64_tr_b16 v[214:215], v69 offset:6144
ds_read_b64_tr_b16 v[216:217], v70 offset:4096
ds_read_b64_tr_b16 v[218:219], v70 offset:6144
ds_read_b64_tr_b16 v[220:221], v71 offset:4096
ds_read_b64_tr_b16 v[222:223], v71 offset:6144
s_waitcnt lgkmcnt(8)
v_mfma_f32_32x32x16_bf16 v[32:47], v[200:203], v[72:75], v[32:47]
ds_read_b64_tr_b16 v[192:193], v68 offset:8192
ds_read_b64_tr_b16 v[194:195], v68 offset:10240
ds_read_b64_tr_b16 v[196:197], v69 offset:8192
v_mfma_f32_32x32x16_bf16 v[48:63], v[204:207], v[72:75], v[48:63]
ds_read_b64_tr_b16 v[198:199], v69 offset:10240
ds_read_b64_tr_b16 v[200:201], v70 offset:8192
v_cvt_pk_bf16_f32 v96, v176, v177
s_waitcnt lgkmcnt(5)
v_mfma_f32_32x32x16_bf16 v[0:15], v[208:211], v[76:79], v[0:15]
ds_read_b64_tr_b16 v[202:203], v70 offset:10240
ds_read_b64_tr_b16 v[204:205], v71 offset:8192
ds_read_b64_tr_b16 v[206:207], v71 offset:10240
v_mfma_f32_32x32x16_bf16 v[16:31], v[212:215], v[76:79], v[16:31]
ds_read_b64_tr_b16 v[208:209], v68 offset:12288
ds_read_b64_tr_b16 v[210:211], v68 offset:14336
ds_read_b64_tr_b16 v[212:213], v69 offset:12288
v_mfma_f32_32x32x16_bf16 v[32:47], v[216:219], v[76:79], v[32:47]
ds_read_b64_tr_b16 v[214:215], v69 offset:14336
ds_read_b64_tr_b16 v[216:217], v70 offset:12288
ds_read_b64_tr_b16 v[218:219], v70 offset:14336
v_mfma_f32_32x32x16_bf16 v[48:63], v[220:223], v[76:79], v[48:63]
ds_read_b64_tr_b16 v[220:221], v71 offset:12288
ds_read_b64_tr_b16 v[222:223], v71 offset:14336
v_cvt_pk_bf16_f32 v97, v178, v179
s_waitcnt lgkmcnt(5)
v_mfma_f32_32x32x16_bf16 v[0:15], v[192:195], v[80:83], v[0:15]
v_cvt_pk_bf16_f32 v98, v180, v181
v_cvt_pk_bf16_f32 v99, v182, v183
v_cvt_pk_bf16_f32 v100, v184, v185
v_cvt_pk_bf16_f32 v101, v186, v187
v_cvt_pk_bf16_f32 v102, v188, v189
v_cvt_pk_bf16_f32 v103, v190, v191
v_mfma_f32_32x32x16_bf16 v[16:31], v[196:199], v[80:83], v[16:31]
s_barrier
ds_read_b128 v[152:155], v245 offset:8192
ds_read_b128 v[156:159], v245 offset:9216
v_mfma_f32_32x32x16_bf16 v[32:47], v[200:203], v[80:83], v[32:47]
ds_read_b64_tr_b16 v[136:137], v64 offset:32768
ds_read_b64_tr_b16 v[138:139], v64 offset:34816
ds_read_b64_tr_b16 v[140:141], v64 offset:36864
ds_read_b64_tr_b16 v[142:143], v64 offset:38912
v_mfma_f32_32x32x16_bf16 v[48:63], v[204:207], v[80:83], v[48:63]
s_waitcnt lgkmcnt(4)
v_and_b32 v152, s57, v152
v_and_b32 v153, s57, v153
v_and_b32 v154, s57, v154
v_and_b32 v155, s57, v155
v_and_b32 v156, s57, v156
v_mfma_f32_32x32x16_bf16 v[0:15], v[208:211], v[84:87], v[0:15]
ds_read_b64_tr_b16 v[192:193], v68 offset:16384
ds_read_b64_tr_b16 v[194:195], v68 offset:18432
ds_read_b64_tr_b16 v[196:197], v69 offset:16384
v_mfma_f32_32x32x16_bf16 v[16:31], v[212:215], v[84:87], v[16:31]
ds_read_b64_tr_b16 v[198:199], v69 offset:18432
ds_read_b64_tr_b16 v[200:201], v70 offset:16384
ds_read_b64_tr_b16 v[202:203], v70 offset:18432
v_mfma_f32_32x32x16_bf16 v[32:47], v[216:219], v[84:87], v[32:47]
ds_read_b64_tr_b16 v[204:205], v71 offset:16384
ds_read_b64_tr_b16 v[206:207], v71 offset:18432
v_and_b32 v157, s57, v157
s_waitcnt lgkmcnt(5)
v_mfma_f32_32x32x16_bf16 v[160:175], v[136:139], v[152:155], 0
v_and_b32 v158, s57, v158
v_and_b32 v159, s57, v159
ds_read_b64_tr_b16 v[144:145], v65 offset:32768
ds_read_b64_tr_b16 v[146:147], v65 offset:34816
ds_read_b64_tr_b16 v[148:149], v65 offset:36864
ds_read_b64_tr_b16 v[150:151], v65 offset:38912
v_mfma_f32_32x32x16_bf16 v[48:63], v[220:223], v[84:87], v[48:63]
ds_read_b64_tr_b16 v[208:209], v68 offset:20480
ds_read_b64_tr_b16 v[210:211], v68 offset:22528
ds_read_b64_tr_b16 v[212:213], v69 offset:20480
v_mfma_f32_32x32x16_bf16 v[160:175], v[140:143], v[156:159], v[160:175]
ds_read_b64_tr_b16 v[214:215], v69 offset:22528
ds_read_b64_tr_b16 v[216:217], v70 offset:20480
ds_read_b64_tr_b16 v[218:219], v70 offset:22528
v_mfma_f32_32x32x16_bf16 v[0:15], v[192:195], v[88:91], v[0:15]
ds_read_b64_tr_b16 v[220:221], v71 offset:20480
ds_read_b64_tr_b16 v[222:223], v71 offset:22528
s_waitcnt lgkmcnt(5)
v_mfma_f32_32x32x16_bf16 v[16:31], v[196:199], v[88:91], v[16:31]
ds_read_b64_tr_b16 v[136:137], v66 offset:32768
ds_read_b64_tr_b16 v[138:139], v66 offset:34816
ds_read_b64_tr_b16 v[140:141], v66 offset:36864
v_mfma_f32_32x32x16_bf16 v[176:191], v[144:147], v[152:155], 0
ds_read_b64_tr_b16 v[142:143], v66 offset:38912
ds_read_b64_tr_b16 v[192:193], v68 offset:24576
ds_read_b64_tr_b16 v[194:195], v68 offset:26624
v_mfma_f32_32x32x16_bf16 v[32:47], v[200:203], v[88:91], v[32:47]
ds_read_b64_tr_b16 v[196:197], v69 offset:24576
ds_read_b64_tr_b16 v[198:199], v69 offset:26624
ds_read_b64_tr_b16 v[200:201], v70 offset:24576
v_mfma_f32_32x32x16_bf16 v[48:63], v[204:207], v[88:91], v[48:63]
v_cvt_pk_bf16_f32 v104, v160, v161
v_cvt_pk_bf16_f32 v105, v162, v163
v_cvt_pk_bf16_f32 v106, v164, v165
v_cvt_pk_bf16_f32 v107, v166, v167
v_cvt_pk_bf16_f32 v108, v168, v169
v_cvt_pk_bf16_f32 v109, v170, v171
v_mfma_f32_32x32x16_bf16 v[176:191], v[148:151], v[156:159], v[176:191]
v_cvt_pk_bf16_f32 v110, v172, v173
v_cvt_pk_bf16_f32 v111, v174, v175
ds_read_b64_tr_b16 v[202:203], v70 offset:26624
ds_read_b64_tr_b16 v[204:205], v71 offset:24576
v_mfma_f32_32x32x16_bf16 v[0:15], v[208:211], v[92:95], v[0:15]
ds_read_b64_tr_b16 v[206:207], v71 offset:26624
ds_read_b64_tr_b16 v[144:145], v67 offset:32768
s_waitcnt lgkmcnt(4)
v_mfma_f32_32x32x16_bf16 v[16:31], v[212:215], v[92:95], v[16:31]
ds_read_b64_tr_b16 v[146:147], v67 offset:34816
ds_read_b64_tr_b16 v[148:149], v67 offset:36864
ds_read_b64_tr_b16 v[150:151], v67 offset:38912
v_mfma_f32_32x32x16_bf16 v[32:47], v[216:219], v[92:95], v[32:47]
ds_read_b64_tr_b16 v[208:209], v68 offset:28672
ds_read_b64_tr_b16 v[210:211], v68 offset:30720
ds_read_b64_tr_b16 v[212:213], v69 offset:28672
v_mfma_f32_32x32x16_bf16 v[160:175], v[136:139], v[152:155], 0
ds_read_b64_tr_b16 v[214:215], v69 offset:30720
ds_read_b64_tr_b16 v[216:217], v70 offset:28672
ds_read_b64_tr_b16 v[218:219], v70 offset:30720
v_mfma_f32_32x32x16_bf16 v[48:63], v[220:223], v[92:95], v[48:63]
ds_read_b64_tr_b16 v[220:221], v71 offset:28672
ds_read_b64_tr_b16 v[222:223], v71 offset:30720
v_cvt_pk_bf16_f32 v112, v176, v177
v_cvt_pk_bf16_f32 v113, v178, v179
v_mfma_f32_32x32x16_bf16 v[160:175], v[140:143], v[156:159], v[160:175]
v_cvt_pk_bf16_f32 v114, v180, v181
v_cvt_pk_bf16_f32 v115, v182, v183
v_cvt_pk_bf16_f32 v116, v184, v185
v_cvt_pk_bf16_f32 v117, v186, v187
v_cvt_pk_bf16_f32 v118, v188, v189
v_cvt_pk_bf16_f32 v119, v190, v191
v_mfma_f32_32x32x16_bf16 v[0:15], v[192:195], v[96:99], v[0:15]
v_mfma_f32_32x32x16_bf16 v[16:31], v[196:199], v[96:99], v[16:31]
s_waitcnt lgkmcnt(0)
v_mfma_f32_32x32x16_bf16 v[32:47], v[200:203], v[96:99], v[32:47]
v_mfma_f32_32x32x16_bf16 v[176:191], v[144:147], v[152:155], 0
v_mfma_f32_32x32x16_bf16 v[48:63], v[204:207], v[96:99], v[48:63]
s_barrier
ds_read_b64_tr_b16 v[192:193], v68 offset:32768
ds_read_b64_tr_b16 v[194:195], v68 offset:34816
v_cvt_pk_bf16_f32 v120, v160, v161
v_mfma_f32_32x32x16_bf16 v[0:15], v[208:211], v[100:103], v[0:15]
ds_read_b64_tr_b16 v[196:197], v69 offset:32768
ds_read_b64_tr_b16 v[198:199], v69 offset:34816
ds_read_b64_tr_b16 v[200:201], v70 offset:32768
v_mfma_f32_32x32x16_bf16 v[176:191], v[148:151], v[156:159], v[176:191]
ds_read_b64_tr_b16 v[202:203], v70 offset:34816
ds_read_b64_tr_b16 v[204:205], v71 offset:32768
ds_read_b64_tr_b16 v[206:207], v71 offset:34816
v_mfma_f32_32x32x16_bf16 v[16:31], v[212:215], v[100:103], v[16:31]
v_cvt_pk_bf16_f32 v121, v162, v163
v_cvt_pk_bf16_f32 v122, v164, v165
v_cvt_pk_bf16_f32 v123, v166, v167
v_cvt_pk_bf16_f32 v124, v168, v169
v_cvt_pk_bf16_f32 v125, v170, v171
v_cvt_pk_bf16_f32 v126, v172, v173
v_mfma_f32_32x32x16_bf16 v[32:47], v[216:219], v[100:103], v[32:47]
v_cvt_pk_bf16_f32 v127, v174, v175
v_mfma_f32_32x32x16_bf16 v[48:63], v[220:223], v[100:103], v[48:63]
s_waitcnt lgkmcnt(0)
v_mfma_f32_32x32x16_bf16 v[0:15], v[192:195], v[104:107], v[0:15]
ds_read_b64_tr_b16 v[208:209], v68 offset:36864
ds_read_b64_tr_b16 v[210:211], v68 offset:38912
ds_read_b64_tr_b16 v[212:213], v69 offset:36864
v_mfma_f32_32x32x16_bf16 v[16:31], v[196:199], v[104:107], v[16:31]
ds_read_b64_tr_b16 v[214:215], v69 offset:38912
ds_read_b64_tr_b16 v[216:217], v70 offset:36864
ds_read_b64_tr_b16 v[218:219], v70 offset:38912
ds_read_b64_tr_b16 v[220:221], v71 offset:36864
ds_read_b64_tr_b16 v[222:223], v71 offset:38912
v_mfma_f32_32x32x16_bf16 v[32:47], v[200:203], v[104:107], v[32:47]
ds_read_b64_tr_b16 v[192:193], v68 offset:40960
ds_read_b64_tr_b16 v[194:195], v68 offset:43008
ds_read_b64_tr_b16 v[196:197], v69 offset:40960
v_mfma_f32_32x32x16_bf16 v[48:63], v[204:207], v[104:107], v[48:63]
ds_read_b64_tr_b16 v[198:199], v69 offset:43008
ds_read_b64_tr_b16 v[200:201], v70 offset:40960
v_cvt_pk_bf16_f32 v128, v176, v177
s_waitcnt lgkmcnt(5)
v_mfma_f32_32x32x16_bf16 v[0:15], v[208:211], v[108:111], v[0:15]
ds_read_b64_tr_b16 v[202:203], v70 offset:43008
ds_read_b64_tr_b16 v[204:205], v71 offset:40960
ds_read_b64_tr_b16 v[206:207], v71 offset:43008
v_mfma_f32_32x32x16_bf16 v[16:31], v[212:215], v[108:111], v[16:31]
ds_read_b64_tr_b16 v[208:209], v68 offset:45056
ds_read_b64_tr_b16 v[210:211], v68 offset:47104
ds_read_b64_tr_b16 v[212:213], v69 offset:45056
v_mfma_f32_32x32x16_bf16 v[32:47], v[216:219], v[108:111], v[32:47]
ds_read_b64_tr_b16 v[214:215], v69 offset:47104
ds_read_b64_tr_b16 v[216:217], v70 offset:45056
ds_read_b64_tr_b16 v[218:219], v70 offset:47104
v_mfma_f32_32x32x16_bf16 v[48:63], v[220:223], v[108:111], v[48:63]
ds_read_b64_tr_b16 v[220:221], v71 offset:45056
ds_read_b64_tr_b16 v[222:223], v71 offset:47104
v_cvt_pk_bf16_f32 v129, v178, v179
s_waitcnt lgkmcnt(5)
v_mfma_f32_32x32x16_bf16 v[0:15], v[192:195], v[112:115], v[0:15]
v_cvt_pk_bf16_f32 v130, v180, v181
v_cvt_pk_bf16_f32 v131, v182, v183
v_cvt_pk_bf16_f32 v132, v184, v185
v_cvt_pk_bf16_f32 v133, v186, v187
v_cvt_pk_bf16_f32 v134, v188, v189
v_cvt_pk_bf16_f32 v135, v190, v191
v_mfma_f32_32x32x16_bf16 v[16:31], v[196:199], v[112:115], v[16:31]
s_barrier
ds_read_b128 v[152:155], v245 offset:0
ds_read_b128 v[156:159], v245 offset:1024
v_mfma_f32_32x32x16_bf16 v[32:47], v[200:203], v[112:115], v[32:47]
ds_read_b64_tr_b16 v[136:137], v64 offset:0
ds_read_b64_tr_b16 v[138:139], v64 offset:2048
ds_read_b64_tr_b16 v[140:141], v64 offset:4096
ds_read_b64_tr_b16 v[142:143], v64 offset:6144
v_mfma_f32_32x32x16_bf16 v[48:63], v[204:207], v[112:115], v[48:63]
s_waitcnt lgkmcnt(4)
v_and_b32 v152, s57, v152
v_and_b32 v153, s57, v153
v_and_b32 v154, s57, v154
v_and_b32 v155, s57, v155
v_and_b32 v156, s57, v156
v_mfma_f32_32x32x16_bf16 v[0:15], v[208:211], v[116:119], v[0:15]
ds_read_b64_tr_b16 v[192:193], v68 offset:49152
ds_read_b64_tr_b16 v[194:195], v68 offset:51200
ds_read_b64_tr_b16 v[196:197], v69 offset:49152
v_mfma_f32_32x32x16_bf16 v[16:31], v[212:215], v[116:119], v[16:31]
ds_read_b64_tr_b16 v[198:199], v69 offset:51200
ds_read_b64_tr_b16 v[200:201], v70 offset:49152
ds_read_b64_tr_b16 v[202:203], v70 offset:51200
v_mfma_f32_32x32x16_bf16 v[32:47], v[216:219], v[116:119], v[32:47]
ds_read_b64_tr_b16 v[204:205], v71 offset:49152
ds_read_b64_tr_b16 v[206:207], v71 offset:51200
v_and_b32 v157, s57, v157
s_waitcnt lgkmcnt(5)
v_mfma_f32_32x32x16_bf16 v[160:175], v[136:139], v[152:155], 0
v_and_b32 v158, s57, v158
v_and_b32 v159, s57, v159
ds_read_b64_tr_b16 v[144:145], v65 offset:0
ds_read_b64_tr_b16 v[146:147], v65 offset:2048
ds_read_b64_tr_b16 v[148:149], v65 offset:4096
ds_read_b64_tr_b16 v[150:151], v65 offset:6144
v_mfma_f32_32x32x16_bf16 v[48:63], v[220:223], v[116:119], v[48:63]
ds_read_b64_tr_b16 v[208:209], v68 offset:53248
ds_read_b64_tr_b16 v[210:211], v68 offset:55296
ds_read_b64_tr_b16 v[212:213], v69 offset:53248
v_mfma_f32_32x32x16_bf16 v[160:175], v[140:143], v[156:159], v[160:175]
ds_read_b64_tr_b16 v[214:215], v69 offset:55296
ds_read_b64_tr_b16 v[216:217], v70 offset:53248
ds_read_b64_tr_b16 v[218:219], v70 offset:55296
v_mfma_f32_32x32x16_bf16 v[0:15], v[192:195], v[120:123], v[0:15]
ds_read_b64_tr_b16 v[220:221], v71 offset:53248
ds_read_b64_tr_b16 v[222:223], v71 offset:55296
s_waitcnt lgkmcnt(5)
v_mfma_f32_32x32x16_bf16 v[16:31], v[196:199], v[120:123], v[16:31]
ds_read_b64_tr_b16 v[136:137], v66 offset:0
ds_read_b64_tr_b16 v[138:139], v66 offset:2048
ds_read_b64_tr_b16 v[140:141], v66 offset:4096
v_mfma_f32_32x32x16_bf16 v[176:191], v[144:147], v[152:155], 0
ds_read_b64_tr_b16 v[142:143], v66 offset:6144
ds_read_b64_tr_b16 v[192:193], v68 offset:57344
ds_read_b64_tr_b16 v[194:195], v68 offset:59392
v_mfma_f32_32x32x16_bf16 v[32:47], v[200:203], v[120:123], v[32:47]
ds_read_b64_tr_b16 v[196:197], v69 offset:57344
ds_read_b64_tr_b16 v[198:199], v69 offset:59392
ds_read_b64_tr_b16 v[200:201], v70 offset:57344
v_mfma_f32_32x32x16_bf16 v[48:63], v[204:207], v[120:123], v[48:63]
v_cvt_pk_bf16_f32 v72, v160, v161
v_cvt_pk_bf16_f32 v73, v162, v163
v_cvt_pk_bf16_f32 v74, v164, v165
v_cvt_pk_bf16_f32 v75, v166, v167
v_cvt_pk_bf16_f32 v76, v168, v169
v_cvt_pk_bf16_f32 v77, v170, v171
v_mfma_f32_32x32x16_bf16 v[176:191], v[148:151], v[156:159], v[176:191]
v_cvt_pk_bf16_f32 v78, v172, v173
v_cvt_pk_bf16_f32 v79, v174, v175
ds_read_b64_tr_b16 v[202:203], v70 offset:59392
ds_read_b64_tr_b16 v[204:205], v71 offset:57344
v_mfma_f32_32x32x16_bf16 v[0:15], v[208:211], v[124:127], v[0:15]
ds_read_b64_tr_b16 v[206:207], v71 offset:59392
ds_read_b64_tr_b16 v[144:145], v67 offset:0
s_waitcnt lgkmcnt(4)
v_mfma_f32_32x32x16_bf16 v[16:31], v[212:215], v[124:127], v[16:31]
ds_read_b64_tr_b16 v[146:147], v67 offset:2048
ds_read_b64_tr_b16 v[148:149], v67 offset:4096
ds_read_b64_tr_b16 v[150:151], v67 offset:6144
v_mfma_f32_32x32x16_bf16 v[32:47], v[216:219], v[124:127], v[32:47]
ds_read_b64_tr_b16 v[208:209], v68 offset:61440
ds_read_b64_tr_b16 v[210:211], v68 offset:63488
ds_read_b64_tr_b16 v[212:213], v69 offset:61440
v_mfma_f32_32x32x16_bf16 v[160:175], v[136:139], v[152:155], 0
ds_read_b64_tr_b16 v[214:215], v69 offset:63488
ds_read_b64_tr_b16 v[216:217], v70 offset:61440
ds_read_b64_tr_b16 v[218:219], v70 offset:63488
v_mfma_f32_32x32x16_bf16 v[48:63], v[220:223], v[124:127], v[48:63]
ds_read_b64_tr_b16 v[220:221], v71 offset:61440
ds_read_b64_tr_b16 v[222:223], v71 offset:63488
v_cvt_pk_bf16_f32 v80, v176, v177
v_cvt_pk_bf16_f32 v81, v178, v179
v_mfma_f32_32x32x16_bf16 v[160:175], v[140:143], v[156:159], v[160:175]
v_cvt_pk_bf16_f32 v82, v180, v181
v_cvt_pk_bf16_f32 v83, v182, v183
v_cvt_pk_bf16_f32 v84, v184, v185
v_cvt_pk_bf16_f32 v85, v186, v187
v_cvt_pk_bf16_f32 v86, v188, v189
v_cvt_pk_bf16_f32 v87, v190, v191
v_mfma_f32_32x32x16_bf16 v[0:15], v[192:195], v[128:131], v[0:15]
v_mfma_f32_32x32x16_bf16 v[16:31], v[196:199], v[128:131], v[16:31]
s_waitcnt lgkmcnt(0)
v_mfma_f32_32x32x16_bf16 v[32:47], v[200:203], v[128:131], v[32:47]
v_mfma_f32_32x32x16_bf16 v[176:191], v[144:147], v[152:155], 0
v_mfma_f32_32x32x16_bf16 v[48:63], v[204:207], v[128:131], v[48:63]
s_barrier
ds_read_b64_tr_b16 v[192:193], v68 offset:0
ds_read_b64_tr_b16 v[194:195], v68 offset:2048
v_cvt_pk_bf16_f32 v88, v160, v161
v_mfma_f32_32x32x16_bf16 v[0:15], v[208:211], v[132:135], v[0:15]
ds_read_b64_tr_b16 v[196:197], v69 offset:0
ds_read_b64_tr_b16 v[198:199], v69 offset:2048
ds_read_b64_tr_b16 v[200:201], v70 offset:0
v_mfma_f32_32x32x16_bf16 v[176:191], v[148:151], v[156:159], v[176:191]
ds_read_b64_tr_b16 v[202:203], v70 offset:2048
ds_read_b64_tr_b16 v[204:205], v71 offset:0
ds_read_b64_tr_b16 v[206:207], v71 offset:2048
v_mfma_f32_32x32x16_bf16 v[16:31], v[212:215], v[132:135], v[16:31]
v_cvt_pk_bf16_f32 v89, v162, v163
v_cvt_pk_bf16_f32 v90, v164, v165
v_cvt_pk_bf16_f32 v91, v166, v167
v_cvt_pk_bf16_f32 v92, v168, v169
v_cvt_pk_bf16_f32 v93, v170, v171
v_cvt_pk_bf16_f32 v94, v172, v173
v_mfma_f32_32x32x16_bf16 v[32:47], v[216:219], v[132:135], v[32:47]
v_cvt_pk_bf16_f32 v95, v174, v175
v_mfma_f32_32x32x16_bf16 v[48:63], v[220:223], v[132:135], v[48:63]
s_add_u32 s47, s47, 1
s_cmp_lt_u32 s47, 2
s_cbranch_scc1 L_p2
L_p2x:
s_waitcnt lgkmcnt(0)
v_mfma_f32_32x32x16_bf16 v[0:15], v[192:195], v[72:75], v[0:15]
ds_read_b64_tr_b16 v[208:209], v68 offset:4096
ds_read_b64_tr_b16 v[210:211], v68 offset:6144
ds_read_b64_tr_b16 v[212:213], v69 offset:4096
v_mfma_f32_32x32x16_bf16 v[16:31], v[196:199], v[72:75], v[16:31]
ds_read_b64_tr_b16 v[214:215], v69 offset:6144
ds_read_b64_tr_b16 v[216:217], v70 offset:4096
ds_read_b64_tr_b16 v[218:219], v70 offset:6144
ds_read_b64_tr_b16 v[220:221], v71 offset:4096
ds_read_b64_tr_b16 v[222:223], v71 offset:6144
v_mfma_f32_32x32x16_bf16 v[32:47], v[200:203], v[72:75], v[32:47]
s_barrier
ds_read_b128 v[152:155], v245 offset:8192
ds_read_b128 v[156:159], v245 offset:9216
v_cvt_pk_bf16_f32 v96, v176, v177
v_mfma_f32_32x32x16_bf16 v[48:63], v[204:207], v[72:75], v[48:63]
ds_read_b64_tr_b16 v[192:193], v68 offset:8192
ds_read_b64_tr_b16 v[194:195], v68 offset:10240
v_cvt_pk_bf16_f32 v97, v178, v179
s_waitcnt lgkmcnt(4)
v_mfma_f32_32x32x16_bf16 v[0:15], v[208:211], v[76:79], v[0:15]
ds_read_b64_tr_b16 v[196:197], v68 offset:12288
ds_read_b64_tr_b16 v[198:199], v68 offset:14336
ds_read_b64_tr_b16 v[200:201], v68 offset:16384
v_mfma_f32_32x32x16_bf16 v[16:31], v[212:215], v[76:79], v[16:31]
ds_read_b64_tr_b16 v[202:203], v68 offset:18432
ds_read_b64_tr_b16 v[204:205], v68 offset:20480
ds_read_b64_tr_b16 v[206:207], v68 offset:22528
ds_read_b64_tr_b16 v[136:137], v64 offset:32768
ds_read_b64_tr_b16 v[138:139], v64 offset:34816
ds_read_b64_tr_b16 v[140:141], v64 offset:36864
ds_read_b64_tr_b16 v[142:143], v64 offset:38912
ds_read_b64_tr_b16 v[144:145], v65 offset:32768
ds_read_b64_tr_b16 v[146:147], v65 offset:34816
v_mfma_f32_32x32x16_bf16 v[32:47], v[216:219], v[76:79], v[32:47]
s_waitcnt lgkmcnt(9)
v_and_b32 v152, s57, v152
v_and_b32 v153, s57, v153
v_and_b32 v154, s57, v154
v_and_b32 v155, s57, v155
v_and_b32 v156, s57, v156
v_mfma_f32_32x32x16_bf16 v[48:63], v[220:223], v[76:79], v[48:63]
v_and_b32 v157, s57, v157
v_and_b32 v158, s57, v158
v_and_b32 v159, s57, v159
ds_read_b64_tr_b16 v[208:209], v68 offset:24576
v_cvt_pk_bf16_f32 v98, v180, v181
v_mfma_f32_32x32x16_bf16 v[0:15], v[192:195], v[80:83], v[0:15]
ds_read_b64_tr_b16 v[210:211], v68 offset:26624
ds_read_b64_tr_b16 v[212:213], v68 offset:28672
v_cvt_pk_bf16_f32 v99, v182, v183
s_waitcnt lgkmcnt(3)
v_mfma_f32_32x32x16_bf16 v[160:175], v[136:139], v[152:155], 0
ds_read_b64_tr_b16 v[214:215], v68 offset:30720
ds_read_b64_tr_b16 v[216:217], v69 offset:8192
ds_read_b64_tr_b16 v[218:219], v69 offset:10240
v_mfma_f32_32x32x16_bf16 v[0:15], v[196:199], v[84:87], v[0:15]
ds_read_b64_tr_b16 v[220:221], v69 offset:12288
ds_read_b64_tr_b16 v[222:223], v69 offset:14336
ds_read_b64_tr_b16 v[148:149], v65 offset:36864
v_mfma_f32_32x32x16_bf16 v[160:175], v[140:143], v[156:159], v[160:175]
ds_read_b64_tr_b16 v[150:151], v65 offset:38912
ds_read_b64_tr_b16 v[136:137], v66 offset:32768
ds_read_b64_tr_b16 v[138:139], v66 offset:34816
v_mfma_f32_32x32x16_bf16 v[0:15], v[200:203], v[88:91], v[0:15]
v_cvt_pk_bf16_f32 v100, v184, v185
v_cvt_pk_bf16_f32 v101, v186, v187
v_cvt_pk_bf16_f32 v102, v188, v189
v_cvt_pk_bf16_f32 v103, v190, v191
ds_read_b64_tr_b16 v[192:193], v69 offset:16384
v_mfma_f32_32x32x16_bf16 v[0:15], v[204:207], v[92:95], v[0:15]
ds_read_b64_tr_b16 v[194:195], v69 offset:18432
ds_read_b64_tr_b16 v[196:197], v69 offset:20480
ds_read_b64_tr_b16 v[198:199], v69 offset:22528
v_mfma_f32_32x32x16_bf16 v[176:191], v[144:147], v[152:155], 0
ds_read_b64_tr_b16 v[200:201], v69 offset:24576
ds_read_b64_tr_b16 v[202:203], v69 offset:26624
s_waitcnt lgkmcnt(5)
v_mfma_f32_32x32x16_bf16 v[0:15], v[208:211], v[96:99], v[0:15]
s_barrier
ds_read_b64_tr_b16 v[204:205], v69 offset:28672
ds_read_b64_tr_b16 v[206:207], v69 offset:30720
v_mfma_f32_32x32x16_bf16 v[176:191], v[148:151], v[156:159], v[176:191]
ds_read_b64_tr_b16 v[140:141], v66 offset:36864
ds_read_b64_tr_b16 v[142:143], v66 offset:38912
ds_read_b64_tr_b16 v[144:145], v67 offset:32768
v_mfma_f32_32x32x16_bf16 v[0:15], v[212:215], v[100:103], v[0:15]
ds_read_b64_tr_b16 v[146:147], v67 offset:34816
ds_read_b64_tr_b16 v[148:149], v67 offset:36864
ds_read_b64_tr_b16 v[150:151], v67 offset:38912
v_mfma_f32_32x32x16_bf16 v[16:31], v[216:219], v[80:83], v[16:31]
v_cvt_pk_bf16_f32 v104, v160, v161
v_cvt_pk_bf16_f32 v105, v162, v163
v_cvt_pk_bf16_f32 v106, v164, v165
v_cvt_pk_bf16_f32 v107, v166, v167
v_cvt_pk_bf16_f32 v108, v168, v169
v_cvt_pk_bf16_f32 v109, v170, v171
v_mfma_f32_32x32x16_bf16 v[16:31], v[220:223], v[84:87], v[16:31]
v_cvt_pk_bf16_f32 v110, v172, v173
v_cvt_pk_bf16_f32 v111, v174, v175
ds_read_b64_tr_b16 v[208:209], v68 offset:32768
ds_read_b64_tr_b16 v[210:211], v68 offset:34816
v_mfma_f32_32x32x16_bf16 v[160:175], v[136:139], v[152:155], 0
ds_read_b64_tr_b16 v[212:213], v68 offset:36864
ds_read_b64_tr_b16 v[214:215], v68 offset:38912
s_waitcnt lgkmcnt(4)
v_mfma_f32_32x32x16_bf16 v[16:31], v[192:195], v[88:91], v[16:31]
v_cvt_pk_bf16_f32 v112, v176, v177
v_cvt_pk_bf16_f32 v113, v178, v179
v_cvt_pk_bf16_f32 v114, v180, v181
v_cvt_pk_bf16_f32 v115, v182, v183
v_cvt_pk_bf16_f32 v116, v184, v185
v_cvt_pk_bf16_f32 v117, v186, v187
v_mfma_f32_32x32x16_bf16 v[160:175], v[140:143], v[156:159], v[160:175]
v_cvt_pk_bf16_f32 v118, v188, v189
v_cvt_pk_bf16_f32 v119, v190, v191
ds_read_b64_tr_b16 v[216:217], v68 offset:40960
ds_read_b64_tr_b16 v[218:219], v68 offset:43008
v_mfma_f32_32x32x16_bf16 v[16:31], v[196:199], v[92:95], v[16:31]
s_barrier
ds_read_b64_tr_b16 v[220:221], v68 offset:45056
ds_read_b64_tr_b16 v[222:223], v68 offset:47104
v_mfma_f32_32x32x16_bf16 v[16:31], v[200:203], v[96:99], v[16:31]
ds_read_b64_tr_b16 v[192:193], v68 offset:49152
ds_read_b64_tr_b16 v[194:195], v68 offset:51200
ds_read_b64_tr_b16 v[196:197], v68 offset:53248
v_mfma_f32_32x32x16_bf16 v[176:191], v[144:147], v[152:155], 0
ds_read_b64_tr_b16 v[198:199], v68 offset:55296
ds_read_b64_tr_b16 v[200:201], v68 offset:57344
ds_read_b64_tr_b16 v[202:203], v68 offset:59392
v_mfma_f32_32x32x16_bf16 v[16:31], v[204:207], v[100:103], v[16:31]
ds_read_b64_tr_b16 v[204:205], v68 offset:61440
ds_read_b64_tr_b16 v[206:207], v68 offset:63488
v_mfma_f32_32x32x16_bf16 v[176:191], v[148:151], v[156:159], v[176:191]
v_cvt_pk_bf16_f32 v120, v160, v161
v_cvt_pk_bf16_f32 v121, v162, v163
v_cvt_pk_bf16_f32 v122, v164, v165
v_cvt_pk_bf16_f32 v123, v166, v167
v_cvt_pk_bf16_f32 v124, v168, v169
s_waitcnt lgkmcnt(2)
v_mfma_f32_32x32x16_bf16 v[0:15], v[208:211], v[104:107], v[0:15]
v_cvt_pk_bf16_f32 v125, v170, v171
v_cvt_pk_bf16_f32 v126, v172, v173
v_cvt_pk_bf16_f32 v127, v174, v175
ds_read_b64_tr_b16 v[208:209], v69 offset:32768
v_mfma_f32_32x32x16_bf16 v[0:15], v[212:215], v[108:111], v[0:15]
ds_read_b64_tr_b16 v[210:211], v69 offset:34816
ds_read_b64_tr_b16 v[212:213], v69 offset:36864
ds_read_b64_tr_b16 v[214:215], v69 offset:38912
v_mfma_f32_32x32x16_bf16 v[0:15], v[216:219], v[112:115], v[0:15]
ds_read_b64_tr_b16 v[216:217], v69 offset:40960
ds_read_b64_tr_b16 v[218:219], v69 offset:43008
v_mfma_f32_32x32x16_bf16 v[0:15], v[220:223], v[116:119], v[0:15]
ds_read_b64_tr_b16 v[220:221], v69 offset:45056
ds_read_b64_tr_b16 v[222:223], v69 offset:47104
v_mfma_f32_32x32x16_bf16 v[0:15], v[192:195], v[120:123], v[0:15]
v_cvt_pk_bf16_f32 v128, v176, v177
v_cvt_pk_bf16_f32 v129, v178, v179
v_cvt_pk_bf16_f32 v130, v180, v181
v_cvt_pk_bf16_f32 v131, v182, v183
v_cvt_pk_bf16_f32 v132, v184, v185
v_cvt_pk_bf16_f32 v133, v186, v187
v_cvt_pk_bf16_f32 v134, v188, v189
v_cvt_pk_bf16_f32 v135, v190, v191
v_mfma_f32_32x32x16_bf16 v[0:15], v[196:199], v[124:127], v[0:15]
ds_read_b64_tr_b16 v[192:193], v69 offset:49152
ds_read_b64_tr_b16 v[194:195], v69 offset:51200
ds_read_b64_tr_b16 v[196:197], v69 offset:53248
v_mfma_f32_32x32x16_bf16 v[0:15], v[200:203], v[128:131], v[0:15]
ds_read_b64_tr_b16 v[198:199], v69 offset:55296
ds_read_b64_tr_b16 v[200:201], v69 offset:57344
s_waitcnt lgkmcnt(5)
v_mfma_f32_32x32x16_bf16 v[0:15], v[204:207], v[132:135], v[0:15]
ds_read_b64_tr_b16 v[202:203], v69 offset:59392
ds_read_b64_tr_b16 v[204:205], v69 offset:61440
ds_read_b64_tr_b16 v[206:207], v69 offset:63488
v_mfma_f32_32x32x16_bf16 v[16:31], v[208:211], v[104:107], v[16:31]
ds_read_b64_tr_b16 v[208:209], v70 offset:8192
ds_read_b64_tr_b16 v[210:211], v70 offset:10240
v_mfma_f32_32x32x16_bf16 v[16:31], v[212:215], v[108:111], v[16:31]
ds_read_b64_tr_b16 v[212:213], v70 offset:12288
ds_read_b64_tr_b16 v[214:215], v70 offset:14336
v_mfma_f32_32x32x16_bf16 v[16:31], v[216:219], v[112:115], v[16:31]
ds_read_b64_tr_b16 v[216:217], v70 offset:16384
ds_read_b64_tr_b16 v[218:219], v70 offset:18432
v_mfma_f32_32x32x16_bf16 v[16:31], v[220:223], v[116:119], v[16:31]
v_cvt_pk_bf16_f32 v136, v0, v1
v_and_or_b32 v136, v136, s73, v244
v_cvt_pk_bf16_f32 v137, v2, v3
v_and_or_b32 v137, v137, s73, v246
v_cvt_pk_bf16_f32 v138, v4, v5
s_waitcnt lgkmcnt(2)
v_mfma_f32_32x32x16_bf16 v[16:31], v[192:195], v[120:123], v[16:31]
ds_read_b64_tr_b16 v[220:221], v70 offset:20480
ds_read_b64_tr_b16 v[222:223], v70 offset:22528
v_and_or_b32 v138, v138, s73, v247
v_cvt_pk_bf16_f32 v139, v6, v7
v_mfma_f32_32x32x16_bf16 v[16:31], v[196:199], v[124:127], v[16:31]
v_and_or_b32 v139, v139, s73, v249
buffer_store_dwordx4 v[136:139], v248, s[20:23], s76 offen offset:0 sc1
v_cvt_pk_bf16_f32 v140, v8, v9
v_and_or_b32 v140, v140, s73, v244
v_cvt_pk_bf16_f32 v141, v10, v11
v_mfma_f32_32x32x16_bf16 v[16:31], v[200:203], v[128:131], v[16:31]
v_and_or_b32 v141, v141, s73, v246
v_cvt_pk_bf16_f32 v142, v12, v13
v_and_or_b32 v142, v142, s73, v247
v_cvt_pk_bf16_f32 v143, v14, v15
v_and_or_b32 v143, v143, s73, v249
v_mfma_f32_32x32x16_bf16 v[16:31], v[204:207], v[132:135], v[16:31]
buffer_store_dwordx4 v[140:143], v248, s[20:23], s76 offen offset:1024 sc1
ds_read_b64_tr_b16 v[192:193], v70 offset:24576
ds_read_b64_tr_b16 v[194:195], v70 offset:26624
v_mfma_f32_32x32x16_bf16 v[32:47], v[208:211], v[80:83], v[32:47]
ds_read_b64_tr_b16 v[196:197], v70 offset:28672
ds_read_b64_tr_b16 v[198:199], v70 offset:30720
ds_read_b64_tr_b16 v[200:201], v70 offset:32768
v_mfma_f32_32x32x16_bf16 v[32:47], v[212:215], v[84:87], v[32:47]
ds_read_b64_tr_b16 v[202:203], v70 offset:34816
ds_read_b64_tr_b16 v[204:205], v70 offset:36864
ds_read_b64_tr_b16 v[206:207], v70 offset:38912
s_waitcnt lgkmcnt(6)
v_mfma_f32_32x32x16_bf16 v[32:47], v[216:219], v[88:91], v[32:47]
ds_read_b64_tr_b16 v[208:209], v70 offset:40960
ds_read_b64_tr_b16 v[210:211], v70 offset:43008
ds_read_b64_tr_b16 v[212:213], v70 offset:45056
v_mfma_f32_32x32x16_bf16 v[32:47], v[220:223], v[92:95], v[32:47]
v_cvt_pk_bf16_f32 v144, v16, v17
v_and_or_b32 v144, v144, s73, v244
v_cvt_pk_bf16_f32 v145, v18, v19
v_and_or_b32 v145, v145, s73, v246
ds_read_b64_tr_b16 v[214:215], v70 offset:47104
v_mfma_f32_32x32x16_bf16 v[32:47], v[192:195], v[96:99], v[32:47]
ds_read_b64_tr_b16 v[216:217], v70 offset:49152
ds_read_b64_tr_b16 v[218:219], v70 offset:51200
v_cvt_pk_bf16_f32 v146, v20, v21
s_waitcnt lgkmcnt(3)
v_mfma_f32_32x32x16_bf16 v[32:47], v[196:199], v[100:103], v[32:47]
ds_read_b64_tr_b16 v[220:221], v70 offset:53248
ds_read_b64_tr_b16 v[222:223], v70 offset:55296
v_and_or_b32 v146, v146, s73, v247
v_cvt_pk_bf16_f32 v147, v22, v23
v_and_or_b32 v147, v147, s73, v249
buffer_store_dwordx4 v[144:147], v248, s[20:23], s77 offen offset:0 sc1
v_mfma_f32_32x32x16_bf16 v[32:47], v[200:203], v[104:107], v[32:47]
v_cvt_pk_bf16_f32 v148, v24, v25
v_and_or_b32 v148, v148, s73, v244
v_cvt_pk_bf16_f32 v149, v26, v27
v_and_or_b32 v149, v149, s73, v246
v_cvt_pk_bf16_f32 v150, v28, v29
v_and_or_b32 v150, v150, s73, v247
v_mfma_f32_32x32x16_bf16 v[32:47], v[204:207], v[108:111], v[32:47]
v_cvt_pk_bf16_f32 v151, v30, v31
v_and_or_b32 v151, v151, s73, v249
buffer_store_dwordx4 v[148:151], v248, s[20:23], s77 offen offset:1024 sc1
ds_read_b64_tr_b16 v[192:193], v70 offset:57344
v_mfma_f32_32x32x16_bf16 v[32:47], v[208:211], v[112:115], v[32:47]
ds_read_b64_tr_b16 v[194:195], v70 offset:59392
ds_read_b64_tr_b16 v[196:197], v70 offset:61440
v_lshrrev_b32 v24, 4, v248
s_waitcnt lgkmcnt(3)
v_mfma_f32_32x32x16_bf16 v[32:47], v[212:215], v[116:119], v[32:47]
ds_read_b64_tr_b16 v[198:199], v70 offset:63488
ds_read_b64_tr_b16 v[200:201], v71 offset:8192
ds_read_b64_tr_b16 v[202:203], v71 offset:10240
ds_read_b64_tr_b16 v[204:205], v71 offset:12288
ds_read_b64_tr_b16 v[206:207], v71 offset:14336
v_mfma_f32_32x32x16_bf16 v[32:47], v[216:219], v[120:123], v[32:47]
ds_read_b64_tr_b16 v[208:209], v71 offset:16384
ds_read_b64_tr_b16 v[210:211], v71 offset:18432
ds_read_b64_tr_b16 v[212:213], v71 offset:20480
v_mfma_f32_32x32x16_bf16 v[32:47], v[220:223], v[124:127], v[32:47]
ds_read_b64_tr_b16 v[214:215], v71 offset:22528
ds_read_b64_tr_b16 v[216:217], v71 offset:24576
v_and_b32 v25, 31, v24
s_waitcnt lgkmcnt(5)
v_mfma_f32_32x32x16_bf16 v[32:47], v[192:195], v[128:131], v[32:47]
ds_read_b64_tr_b16 v[218:219], v71 offset:26624
ds_read_b64_tr_b16 v[220:221], v71 offset:28672
ds_read_b64_tr_b16 v[222:223], v71 offset:30720
v_mfma_f32_32x32x16_bf16 v[32:47], v[196:199], v[132:135], v[32:47]
ds_read_b64_tr_b16 v[192:193], v71 offset:32768
ds_read_b64_tr_b16 v[194:195], v71 offset:34816
ds_read_b64_tr_b16 v[196:197], v71 offset:36864
v_mfma_f32_32x32x16_bf16 v[48:63], v[200:203], v[80:83], v[48:63]
ds_read_b64_tr_b16 v[198:199], v71 offset:38912
ds_read_b64_tr_b16 v[200:201], v71 offset:40960
ds_read_b64_tr_b16 v[202:203], v71 offset:43008
v_mfma_f32_32x32x16_bf16 v[48:63], v[204:207], v[84:87], v[48:63]
ds_read_b64_tr_b16 v[204:205], v71 offset:45056
ds_read_b64_tr_b16 v[206:207], v71 offset:47104
v_mul_u32_u24 v25, 2304, v25
s_waitcnt lgkmcnt(5)
v_mfma_f32_32x32x16_bf16 v[48:63], v[208:211], v[88:91], v[48:63]
ds_read_b64_tr_b16 v[208:209], v71 offset:49152
ds_read_b64_tr_b16 v[210:211], v71 offset:51200
v_lshrrev_b32 v26, 5, v24
v_lshl_add_u32 v25, v26, 4, v25
v_mfma_f32_32x32x16_bf16 v[48:63], v[212:215], v[92:95], v[48:63]
v_cvt_pk_bf16_f32 v152, v32, v33
v_and_or_b32 v152, v152, s73, v244
v_cvt_pk_bf16_f32 v153, v34, v35
v_and_or_b32 v153, v153, s73, v246
v_cvt_pk_bf16_f32 v154, v36, v37
v_and_or_b32 v154, v154, s73, v247
v_mfma_f32_32x32x16_bf16 v[48:63], v[216:219], v[96:99], v[48:63]
v_cvt_pk_bf16_f32 v155, v38, v39
v_and_or_b32 v155, v155, s73, v249
buffer_store_dwordx4 v[152:155], v248, s[20:23], s78 offen offset:0 sc1
v_cvt_pk_bf16_f32 v156, v40, v41
v_and_or_b32 v156, v156, s73, v244
v_mfma_f32_32x32x16_bf16 v[48:63], v[220:223], v[100:103], v[48:63]
v_cvt_pk_bf16_f32 v157, v42, v43
v_and_or_b32 v157, v157, s73, v246
ds_read_b64_tr_b16 v[212:213], v71 offset:53248
ds_read_b64_tr_b16 v[214:215], v71 offset:55296
v_mfma_f32_32x32x16_bf16 v[48:63], v[192:195], v[104:107], v[48:63]
ds_read_b64_tr_b16 v[216:217], v71 offset:57344
ds_read_b64_tr_b16 v[218:219], v71 offset:59392
v_cvt_pk_bf16_f32 v158, v44, v45
s_waitcnt lgkmcnt(4)
v_mfma_f32_32x32x16_bf16 v[48:63], v[196:199], v[108:111], v[48:63]
ds_read_b64_tr_b16 v[220:221], v71 offset:61440
ds_read_b64_tr_b16 v[222:223], v71 offset:63488
v_and_or_b32 v158, v158, s73, v247
v_cvt_pk_bf16_f32 v159, v46, v47
v_and_or_b32 v159, v159, s73, v249
buffer_store_dwordx4 v[156:159], v248, s[20:23], s78 offen offset:1024 sc1
buffer_load_dwordx4 v[176:179], v248, s[20:23], s88 offen offset:0 sc1
buffer_load_dwordx4 v[180:183], v248, s[20:23], s88 offen offset:1024 sc1
v_mfma_f32_32x32x16_bf16 v[48:63], v[200:203], v[112:115], v[48:63]
v_mov_b32 v27, 0x8000
v_mfma_f32_32x32x16_bf16 v[48:63], v[204:207], v[116:119], v[48:63]
v_mfma_f32_32x32x16_bf16 v[48:63], v[208:211], v[120:123], v[48:63]
buffer_load_dwordx4 v[168:171], v248, s[20:23], s87 offen offset:0 sc1
buffer_load_dwordx4 v[172:175], v248, s[20:23], s87 offen offset:1024 sc1
s_waitcnt lgkmcnt(0)
v_mfma_f32_32x32x16_bf16 v[48:63], v[212:215], v[124:127], v[48:63]
v_mfma_f32_32x32x16_bf16 v[48:63], v[216:219], v[128:131], v[48:63]
v_mfma_f32_32x32x16_bf16 v[48:63], v[220:223], v[132:135], v[48:63]
buffer_load_dwordx4 v[160:163], v248, s[20:23], s86 offen offset:0 sc1
buffer_load_dwordx4 v[164:167], v248, s[20:23], s86 offen offset:1024 sc1
s_mov_b32 s59, 0
s_nop 7
s_waitcnt vmcnt(4)
L_x2:
v_xor_b32 v176, v176, v244
v_xor_b32 v177, v177, v246
v_xor_b32 v178, v178, v247
v_xor_b32 v179, v179, v249
v_xor_b32 v180, v180, v244
v_xor_b32 v181, v181, v246
v_xor_b32 v182, v182, v247
v_xor_b32 v183, v183, v249
v_or3_b32 v28, v176, v177, v178
v_or3_b32 v29, v179, v180, v181
v_or3_b32 v28, v28, v182, v183
v_or_b32 v28, v28, v29
v_and_b32 v28, s74, v28
v_cmp_ne_u32 vcc, 0, v28
s_cbranch_vccz L_x2x
buffer_load_dwordx4 v[176:179], v248, s[20:23], s88 offen offset:0 sc1
buffer_load_dwordx4 v[180:183], v248, s[20:23], s88 offen offset:1024 sc1
s_add_u32 s59, s59, 1
s_waitcnt vmcnt(0)
s_cmp_lt_u32 s59, 262144
s_cbranch_scc1 L_x2
L_x2x:
v_lshl_or_b32 v30, v176, 16, v27
v_and_or_b32 v31, v176, s14, v27
v_pk_add_f32 v[48:49], v[48:49], v[30:31]
v_lshl_or_b32 v30, v177, 16, v27
v_and_or_b32 v31, v177, s14, v27
v_pk_add_f32 v[50:51], v[50:51], v[30:31]
v_lshl_or_b32 v30, v178, 16, v27
v_and_or_b32 v31, v178, s14, v27
v_pk_add_f32 v[52:53], v[52:53], v[30:31]
v_lshl_or_b32 v30, v179, 16, v27
v_and_or_b32 v31, v179, s14, v27
v_pk_add_f32 v[54:55], v[54:55], v[30:31]
v_lshl_or_b32 v30, v180, 16, v27
v_and_or_b32 v31, v180, s14, v27
v_pk_add_f32 v[56:57], v[56:57], v[30:31]
v_lshl_or_b32 v30, v181, 16, v27
v_and_or_b32 v31, v181, s14, v27
v_pk_add_f32 v[58:59], v[58:59], v[30:31]
v_lshl_or_b32 v30, v182, 16, v27
v_and_or_b32 v31, v182, s14, v27
v_pk_add_f32 v[60:61], v[60:61], v[30:31]
v_lshl_or_b32 v30, v183, 16, v27
v_and_or_b32 v31, v183, s14, v27
v_pk_add_f32 v[62:63], v[62:63], v[30:31]
s_waitcnt vmcnt(2)
L_x1:
v_xor_b32 v168, v168, v244
v_xor_b32 v169, v169, v246
v_xor_b32 v170, v170, v247
v_xor_b32 v171, v171, v249
v_xor_b32 v172, v172, v244
v_xor_b32 v173, v173, v246
v_xor_b32 v174, v174, v247
v_xor_b32 v175, v175, v249
v_or3_b32 v28, v168, v169, v170
v_or3_b32 v29, v171, v172, v173
v_or3_b32 v28, v28, v174, v175
v_or_b32 v28, v28, v29
v_and_b32 v28, s74, v28
v_cmp_ne_u32 vcc, 0, v28
s_cbranch_vccz L_x1x
buffer_load_dwordx4 v[168:171], v248, s[20:23], s87 offen offset:0 sc1
buffer_load_dwordx4 v[172:175], v248, s[20:23], s87 offen offset:1024 sc1
s_add_u32 s59, s59, 1
s_waitcnt vmcnt(0)
s_cmp_lt_u32 s59, 262144
s_cbranch_scc1 L_x1
L_x1x:
v_lshl_or_b32 v30, v168, 16, v27
v_and_or_b32 v31, v168, s14, v27
v_pk_add_f32 v[48:49], v[48:49], v[30:31]
v_lshl_or_b32 v30, v169, 16, v27
v_and_or_b32 v31, v169, s14, v27
v_pk_add_f32 v[50:51], v[50:51], v[30:31]
v_lshl_or_b32 v30, v170, 16, v27
v_and_or_b32 v31, v170, s14, v27
v_pk_add_f32 v[52:53], v[52:53], v[30:31]
v_lshl_or_b32 v30, v171, 16, v27
v_and_or_b32 v31, v171, s14, v27
v_pk_add_f32 v[54:55], v[54:55], v[30:31]
v_lshl_or_b32 v30, v172, 16, v27
v_and_or_b32 v31, v172, s14, v27
v_pk_add_f32 v[56:57], v[56:57], v[30:31]
v_lshl_or_b32 v30, v173, 16, v27
v_and_or_b32 v31, v173, s14, v27
v_pk_add_f32 v[58:59], v[58:59], v[30:31]
v_lshl_or_b32 v30, v174, 16, v27
v_and_or_b32 v31, v174, s14, v27
v_pk_add_f32 v[60:61], v[60:61], v[30:31]
v_lshl_or_b32 v30, v175, 16, v27
v_and_or_b32 v31, v175, s14, v27
v_pk_add_f32 v[62:63], v[62:63], v[30:31]
s_waitcnt vmcnt(0)
L_x0:
v_xor_b32 v160, v160, v244
v_xor_b32 v161, v161, v246
v_xor_b32 v162, v162, v247
v_xor_b32 v163, v163, v249
v_xor_b32 v164, v164, v244
v_xor_b32 v165, v165, v246
v_xor_b32 v166, v166, v247
v_xor_b32 v167, v167, v249
v_or3_b32 v28, v160, v161, v162
v_or3_b32 v29, v163, v164, v165
v_or3_b32 v28, v28, v166, v167
v_or_b32 v28, v28, v29
v_and_b32 v28, s74, v28
v_cmp_ne_u32 vcc, 0, v28
s_cbranch_vccz L_x0x
buffer_load_dwordx4 v[160:163], v248, s[20:23], s86 offen offset:0 sc1
buffer_load_dwordx4 v[164:167], v248, s[20:23], s86 offen offset:1024 sc1
s_add_u32 s59, s59, 1
s_waitcnt vmcnt(0)
s_cmp_lt_u32 s59, 262144
s_cbranch_scc1 L_x0
L_x0x:
v_lshl_or_b32 v30, v160, 16, v27
v_and_or_b32 v31, v160, s14, v27
v_pk_add_f32 v[48:49], v[48:49], v[30:31]
v_lshl_or_b32 v30, v161, 16, v27
v_and_or_b32 v31, v161, s14, v27
v_pk_add_f32 v[50:51], v[50:51], v[30:31]
v_lshl_or_b32 v30, v162, 16, v27
v_and_or_b32 v31, v162, s14, v27
v_pk_add_f32 v[52:53], v[52:53], v[30:31]
v_lshl_or_b32 v30, v163, 16, v27
v_and_or_b32 v31, v163, s14, v27
v_pk_add_f32 v[54:55], v[54:55], v[30:31]
v_lshl_or_b32 v30, v164, 16, v27
v_and_or_b32 v31, v164, s14, v27
v_pk_add_f32 v[56:57], v[56:57], v[30:31]
v_lshl_or_b32 v30, v165, 16, v27
v_and_or_b32 v31, v165, s14, v27
v_pk_add_f32 v[58:59], v[58:59], v[30:31]
v_lshl_or_b32 v30, v166, 16, v27
v_and_or_b32 v31, v166, s14, v27
v_pk_add_f32 v[60:61], v[60:61], v[30:31]
v_lshl_or_b32 v30, v167, 16, v27
v_and_or_b32 v31, v167, s14, v27
v_pk_add_f32 v[62:63], v[62:63], v[30:31]
v_cvt_pk_bf16_f32 v48, v48, v49
v_cvt_pk_bf16_f32 v49, v50, v51
v_cvt_pk_bf16_f32 v50, v52, v53
v_cvt_pk_bf16_f32 v51, v54, v55
v_cvt_pk_bf16_f32 v52, v56, v57
v_cvt_pk_bf16_f32 v53, v58, v59
v_cvt_pk_bf16_f32 v54, v60, v61
v_cvt_pk_bf16_f32 v55, v62, v63
s_nop 1
v_permlane32_swap_b32 v48, v50
v_permlane32_swap_b32 v49, v51
v_permlane32_swap_b32 v52, v54
v_permlane32_swap_b32 v53, v55
buffer_store_dwordx4 v[48:51], v25, s[8:11], s12 offen offset:0
buffer_store_dwordx4 v[52:55], v25, s[8:11], s12 offen offset:32
s_endpgm
L_kread:
s_cmp_eq_u32 s64, s65
s_cbranch_scc1 L_kread1
s_waitcnt vmcnt(0)
v_readfirstlane_b32 s56, v238
s_mov_b32 s64, s65
s_add_u32 s56, s56, 1
v_xor_b32 v250, 0, v249
ds_read_b64 v[176:177], v250 offset:0
ds_read_b64 v[180:181], v250 offset:8
v_xor_b32 v250, 32, v249
ds_read_b64 v[178:179], v250 offset:0
ds_read_b64 v[182:183], v250 offset:8
v_xor_b32 v250, 64, v249
ds_read_b64 v[184:185], v250 offset:0
ds_read_b64 v[188:189], v250 offset:8
v_xor_b32 v250, 96, v249
ds_read_b64 v[186:187], v250 offset:0
ds_read_b64 v[190:191], v250 offset:8
v_xor_b32 v250, 128, v249
ds_read_b64 v[192:193], v250 offset:0
ds_read_b64 v[196:197], v250 offset:8
v_xor_b32 v250, 160, v249
ds_read_b64 v[194:195], v250 offset:0
ds_read_b64 v[198:199], v250 offset:8
v_xor_b32 v250, 192, v249
ds_read_b64 v[200:201], v250 offset:0
ds_read_b64 v[204:205], v250 offset:8
v_xor_b32 v250, 224, v249
ds_read_b64 v[202:203], v250 offset:0
ds_read_b64 v[206:207], v250 offset:8
s_setpc_b64 s[70:71]
L_kread1:
v_xor_b32 v250, 0, v249
ds_read_b64 v[208:209], v250 offset:0
ds_read_b64 v[212:213], v250 offset:8
v_xor_b32 v250, 32, v249
ds_read_b64 v[210:211], v250 offset:0
ds_read_b64 v[214:215], v250 offset:8
v_xor_b32 v250, 64, v249
ds_read_b64 v[216:217], v250 offset:0
ds_read_b64 v[220:221], v250 offset:8
v_xor_b32 v250, 96, v249
ds_read_b64 v[218:219], v250 offset:0
ds_read_b64 v[222:223], v250 offset:8
v_xor_b32 v250, 128, v249
ds_read_b64 v[224:225], v250 offset:0
ds_read_b64 v[228:229], v250 offset:8
v_xor_b32 v250, 160, v249
ds_read_b64 v[226:227], v250 offset:0
ds_read_b64 v[230:231], v250 offset:8
v_xor_b32 v250, 192, v249
ds_read_b64 v[232:233], v250 offset:0
ds_read_b64 v[236:237], v250 offset:8
v_xor_b32 v250, 224, v249
ds_read_b64 v[234:235], v250 offset:0
ds_read_b64 v[238:239], v250 offset:8
s_setpc_b64 s[70:71]
L_last:
.section .rodata,"a"
.p2align 6
.amdhsa_kernel concat_heads__mha_block_cached__mha_block_cached__near_ridge_kernel
  .amdhsa_next_free_vgpr 256
  .amdhsa_next_free_sgpr 102
  .amdhsa_accum_offset 256
  .amdhsa_group_segment_fixed_size 0
  .amdhsa_kernarg_size 104
  .amdhsa_user_sgpr_count 2
  .amdhsa_user_sgpr_kernarg_segment_ptr 1
  .amdhsa_system_sgpr_workgroup_id_x 1
.end_amdhsa_kernel
```
